```python
import torch

def _softmax(x, axis=-1):
    return torch.softmax(x, dim=axis)
def _gelu(x):
    return torch.nn.functional.gelu(x, approximate="tanh")
def _silu(x):
    return torch.nn.functional.silu(x)
def _sigmoid(x):
    return torch.sigmoid(x)
def _layernorm(x, axis=-1, eps=1e-5):
    m = x.mean(dim=axis, keepdim=True)
    v = x.var(dim=axis, keepdim=True, unbiased=False)
    return (x - m) / torch.sqrt(v + eps)
def _scatter_add(tgt, idx, src, axis=0):
    return tgt.clone().index_add_(axis, idx, src)
def _segment_sum(src, seg, n):
    out = torch.zeros((n,) + src.shape[1:], dtype=src.dtype)
    return out.index_add_(0, seg, src)
def _pad(x, pw):
    flat = tuple(v for pair in reversed(pw) for v in pair)
    return torch.nn.functional.pad(x, flat)

kernel_name = 'recurrent_scan__ssm_conv_s5__glu_gated_reglu__prompt'

def setup_inputs():

    _w = (lambda a: (lambda t: t.to(torch.bfloat16) if t.is_floating_point() else t)(torch.as_tensor(a)))
    def _A_setup():
        B, S, D = 1, 2048, 512
        P = D
        Lambda_re = -0.5 * (lambda _x: torch.exp(torch.as_tensor(_x)))((lambda *s: torch.randn(*s, dtype=torch.bfloat16) * 0.8)(P))
        Lambda_im = (lambda *s: torch.randn(*s, dtype=torch.bfloat16) * 0.8)(P) * 1.0
        B_re = (lambda *s: torch.randn(*s, dtype=torch.bfloat16) * 0.8)(P, D) * (D ** -0.5)
        B_im = (lambda *s: torch.randn(*s, dtype=torch.bfloat16) * 0.8)(P, D) * (D ** -0.5)
        C_re = (lambda *s: torch.randn(*s, dtype=torch.bfloat16) * 0.8)(D, P) * (P ** -0.5)
        C_im = (lambda *s: torch.randn(*s, dtype=torch.bfloat16) * 0.8)(D, P) * (P ** -0.5)
        log_dt = (lambda *s: torch.randn(*s, dtype=torch.bfloat16) * 0.8)(P) * 0.3 - 2.0
        Dskip = (lambda *s: torch.randn(*s, dtype=torch.bfloat16) * 0.8)(D)
        return {
            "x": _w((lambda *s: torch.randn(*s, dtype=torch.bfloat16) * 0.05)(B, S, D)),
            "Lambda_re": _w(Lambda_re),
            "Lambda_im": _w(Lambda_im),
            "B_re": _w(B_re),
            "B_im": _w(B_im),
            "C_re": _w(C_re),
            "C_im": _w(C_im),
            "log_dt": _w(log_dt),
            "Dskip": _w(Dskip),
        }
    _A_in = _A_setup()

    def _B_setup():
        B, S, D, F = 1, 2048, 512, 1376
        return {
            "x": _w((lambda *s: torch.randn(*s, dtype=torch.bfloat16) * 0.05)(B, S, D)),
            "W_gate": _w((lambda *s: torch.randn(*s, dtype=torch.bfloat16) * 0.2)(D, F) * (2.0 / D) ** 0.5),
            "W_up": _w((lambda *s: torch.randn(*s, dtype=torch.bfloat16) * 0.2)(D, F) * (2.0 / D) ** 0.5),
            "W_down": _w((lambda *s: torch.randn(*s, dtype=torch.bfloat16) * 0.2)(F, D) * (1.0 / F) ** 0.5),
        }
    _B_in = _B_setup()

    return {
        "A_x": _A_in["x"],
        "A_Lambda_re": _A_in["Lambda_re"],
        "A_Lambda_im": _A_in["Lambda_im"],
        "A_B_re": _A_in["B_re"],
        "A_B_im": _A_in["B_im"],
        "A_C_re": _A_in["C_re"],
        "A_C_im": _A_in["C_im"],
        "A_log_dt": _A_in["log_dt"],
        "A_Dskip": _A_in["Dskip"],
        "B_x": _B_in["x"],
        "B_W_gate": _B_in["W_gate"],
        "B_W_up": _B_in["W_up"],
        "B_W_down": _B_in["W_down"],
    }

def reference(A_x, A_Lambda_re, A_Lambda_im, A_B_re, A_B_im, A_C_re, A_C_im, A_log_dt, A_Dskip, B_x, B_W_gate, B_W_up, B_W_down):
    def _A_ref(x, Lambda_re, Lambda_im, B_re, B_im, C_re, C_im, log_dt, Dskip):
        Bsz, L, H = x.shape
        Lam = Lambda_re + 1j * Lambda_im
        Bmat = B_re + 1j * B_im
        Cmat = C_re + 1j * C_im
        dt = torch.exp(log_dt)
        Lam_bar = torch.exp(dt * Lam)
        B_bar = ((Lam_bar - 1.0) / Lam)[:, None] * Bmat
        Bu = torch.einsum("bld,pd->blp", x + 0j, B_bar)
        h = torch.zeros_like(Bu[:, 0, :])
        hs = []
        for t in range(L):
            h = Lam_bar[None, :] * h + Bu[:, t, :]
            hs.append(h)
        hseq = torch.stack(hs, 1)
        y = 2.0 * torch.einsum("blp,dp->bld", hseq, Cmat).real + x * Dskip[None, None, :]
        return y

    def _B_ref(x, W_gate, W_up, W_down):
        gate = torch.einsum("bsd,df->bsf", x, W_gate)
        up = torch.einsum("bsd,df->bsf", x, W_up)
        gate = gate * (lambda x, dt: x.to(dt))(gate > 0, gate.dtype)
        h = gate * up
        return torch.einsum("bsf,fd->bsd", h, W_down)

    x = A_x
    xn = _layernorm(x, axis=-1)
    s = _A_ref(xn, A_Lambda_re, A_Lambda_im, A_B_re, A_B_im, A_C_re, A_C_im, A_log_dt, A_Dskip)
    g = _silu(_B_ref(xn, B_W_gate, B_W_up, B_W_down))
    return x + s * g
```

```asm
; @launch grid=(256,1,1) block=(512,1,1) lds=163840
.amdgcn_target "amdgcn-amd-amdhsa--gfx950"
.text
.globl recurrent_scan__ssm_conv_s5__glu_gated_reglu__prompt_kernel
.p2align 8
.type recurrent_scan__ssm_conv_s5__glu_gated_reglu__prompt_kernel,@function
recurrent_scan__ssm_conv_s5__glu_gated_reglu__prompt_kernel:
    s_cmp_ge_u32 s2, 256
    s_cbranch_scc1 L_end
    s_memrealtime s[98:99]
    s_load_dwordx16 s[16:31], s[0:1], 0
    s_load_dwordx4 s[32:35], s[0:1], 80
    s_load_dwordx4 s[36:39], s[0:1], 96
    s_load_dwordx4 s[40:43], s[0:1], 112
    s_load_dwordx2 s[44:45], s[0:1], 64
    v_and_b32 v1, 63, v0
    v_lshrrev_b32 v8, 6, v0
    v_mov_b32 v4, 0
    s_mov_b32 s3, 0
    v_readfirstlane_b32 s72, v8
    v_lshrrev_b32 v2, 5, v1
    v_lshlrev_b32 v5, 4, v1
    s_and_b32 s79, s2, 7
    s_lshr_b32 s80, s2, 3
    s_and_b32 s74, s79, 1
    s_lshl_b32 s74, s74, 3
    s_and_b32 s78, s80, 7
    s_add_u32 s74, s74, s78
    s_lshr_b32 s75, s79, 1
    s_lshl_b32 s75, s75, 2
    s_lshr_b32 s82, s80, 3
    s_add_u32 s75, s75, s82
    s_and_b32 s76, s79, 3
    s_lshl_b32 s76, s76, 3
    s_add_u32 s76, s76, s78
    s_and_b32 s77, s79, 4
    s_add_u32 s77, s77, s82
    s_and_b32 s73, s72, 3
    s_and_b32 s100, s2, 6
    s_and_b32 s79, s2, 1
    s_lshl_b32 s79, s79, 2
    s_add_u32 s100, s100, s79
    s_mul_i32 s79, s78, 2
    s_add_u32 s100, s100, s79
    s_cmp_lt_u32 s72, 4
    s_cbranch_scc1 L_comp
    s_cmp_lt_u32 s73, 2
    s_cbranch_scc0 L_wrk
    v_lshrrev_b32 v8, 3, v1
    v_and_b32 v9, 7, v1
    v_lshrrev_b32 v10, 1, v8
    v_xor_b32 v11, v9, v10
    v_xor_b32 v10, 4, v11
    s_lshl_b32 s79, s74, 7
    s_lshl_b32 s80, s73, 6
    s_add_u32 s79, s79, s80
    s_lshl_b32 s80, s75, 5
    v_add_u32 v9, s79, v8
    v_lshlrev_b32 v9, 10, v9
    v_lshl_add_u32 v28, v11, 4, v9
    v_lshl_add_u32 v29, v10, 4, v9
    v_add_u32 v29, 7168, v29
    v_add_u32 v30, 14336, v28
    v_add_u32 v31, 14336, v29
    v_add_u32 v9, s80, v8
    v_lshlrev_b32 v9, 10, v9
    v_lshl_add_u32 v32, v11, 4, v9
    v_lshl_add_u32 v33, v10, 4, v9
    v_add_u32 v33, 7168, v33
    v_add_u32 v34, 14336, v32
    v_add_u32 v35, 14336, v33
    v_lshrrev_b32 v8, 2, v1
    v_mul_u32_u24 v36, 2752, v8
    v_and_b32 v9, 3, v1
    v_lshl_add_u32 v36, v9, 4, v36
    s_mul_i32 s79, s75, 192
    v_add_u32 v36, s79, v36
    s_lshl_b32 s83, s73, 13
    s_lshl_b32 s86, s73, 12
    s_add_u32 s84, s86, 16384
    s_mul_i32 s85, s73, 12288
    s_add_u32 s85, s85, 24576
    s_waitcnt lgkmcnt(0)
    s_mov_b32 s48, s16
    s_mov_b32 s49, s17
    s_mov_b32 s50, 2097152
    s_mov_b32 s51, 0x20000
    s_cmp_eq_u32 s73, 0
    s_cselect_b32 s52, s22, s24
    s_cselect_b32 s53, s23, s25
    s_mov_b32 s54, 0x80000
    s_mov_b32 s55, 0x20000
    s_cselect_b32 s56, s32, s34
    s_cselect_b32 s57, s33, s35
    s_mov_b32 s58, 1409024
    s_mov_b32 s59, 0x20000
    s_add_u32 s92, s100, 0
    s_and_b32 s92, s92, 7
    s_mul_i32 s93, s92, 176128
    s_lshl_b32 s92, s92, 7
    s_add_u32 s82, s92, 32768
    s_add_u32 m0, s83, 0
    s_nop 0
    buffer_load_dwordx4 v28, s[48:51], s92 offen offset:0 lds
    buffer_load_dwordx4 v29, s[48:51], s92 offen offset:1024 lds
    buffer_load_dwordx4 v30, s[48:51], s92 offen offset:2048 lds
    buffer_load_dwordx4 v31, s[48:51], s92 offen offset:3072 lds
    s_add_u32 m0, s83, 4096
    s_nop 0
    buffer_load_dwordx4 v28, s[48:51], s82 offen offset:0 lds
    buffer_load_dwordx4 v29, s[48:51], s82 offen offset:1024 lds
    buffer_load_dwordx4 v30, s[48:51], s82 offen offset:2048 lds
    buffer_load_dwordx4 v31, s[48:51], s82 offen offset:3072 lds
    s_add_u32 m0, s84, 0
    s_nop 0
    buffer_load_dwordx4 v32, s[52:55], s92 offen offset:0 lds
    buffer_load_dwordx4 v33, s[52:55], s92 offen offset:1024 lds
    buffer_load_dwordx4 v34, s[52:55], s92 offen offset:2048 lds
    buffer_load_dwordx4 v35, s[52:55], s92 offen offset:3072 lds
    s_add_u32 m0, s85, 0
    s_add_u32 s82, s93, 0
    buffer_load_dwordx4 v36, s[56:59], s82 offen offset:0 lds
    s_add_u32 m0, m0, 960
    s_nop 0
    buffer_load_dwordx4 v36, s[56:59], s82 offen offset:64 lds
    s_add_u32 m0, m0, 960
    s_nop 0
    buffer_load_dwordx4 v36, s[56:59], s82 offen offset:128 lds
    s_add_u32 m0, s85, 3072
    s_add_u32 s82, s93, 44032
    buffer_load_dwordx4 v36, s[56:59], s82 offen offset:0 lds
    s_add_u32 m0, m0, 960
    s_nop 0
    buffer_load_dwordx4 v36, s[56:59], s82 offen offset:64 lds
    s_add_u32 m0, m0, 960
    s_nop 0
    buffer_load_dwordx4 v36, s[56:59], s82 offen offset:128 lds
    s_add_u32 m0, s85, 6144
    s_add_u32 s82, s93, 88064
    buffer_load_dwordx4 v36, s[56:59], s82 offen offset:0 lds
    s_add_u32 m0, m0, 960
    s_nop 0
    buffer_load_dwordx4 v36, s[56:59], s82 offen offset:64 lds
    s_add_u32 m0, m0, 960
    s_nop 0
    buffer_load_dwordx4 v36, s[56:59], s82 offen offset:128 lds
    s_add_u32 m0, s85, 9216
    s_add_u32 s82, s93, 132096
    buffer_load_dwordx4 v36, s[56:59], s82 offen offset:0 lds
    s_add_u32 m0, m0, 960
    s_nop 0
    buffer_load_dwordx4 v36, s[56:59], s82 offen offset:64 lds
    s_add_u32 m0, m0, 960
    s_nop 0
    buffer_load_dwordx4 v36, s[56:59], s82 offen offset:128 lds
    s_add_u32 s92, s100, 1
    s_and_b32 s92, s92, 7
    s_mul_i32 s93, s92, 176128
    s_lshl_b32 s92, s92, 7
    s_add_u32 s82, s92, 32768
    s_add_u32 m0, s83, 49152
    s_nop 0
    buffer_load_dwordx4 v28, s[48:51], s92 offen offset:0 lds
    buffer_load_dwordx4 v29, s[48:51], s92 offen offset:1024 lds
    buffer_load_dwordx4 v30, s[48:51], s92 offen offset:2048 lds
    buffer_load_dwordx4 v31, s[48:51], s92 offen offset:3072 lds
    s_add_u32 m0, s83, 53248
    s_nop 0
    buffer_load_dwordx4 v28, s[48:51], s82 offen offset:0 lds
    buffer_load_dwordx4 v29, s[48:51], s82 offen offset:1024 lds
    buffer_load_dwordx4 v30, s[48:51], s82 offen offset:2048 lds
    buffer_load_dwordx4 v31, s[48:51], s82 offen offset:3072 lds
    s_add_u32 m0, s84, 49152
    s_nop 0
    buffer_load_dwordx4 v32, s[52:55], s92 offen offset:0 lds
    buffer_load_dwordx4 v33, s[52:55], s92 offen offset:1024 lds
    buffer_load_dwordx4 v34, s[52:55], s92 offen offset:2048 lds
    buffer_load_dwordx4 v35, s[52:55], s92 offen offset:3072 lds
    s_mov_b32 s68, s36
    s_mov_b32 s69, s37
    s_mov_b32 s70, 1409024
    s_mov_b32 s71, 0x20000
    s_mov_b32 s64, s42
    s_mov_b32 s65, s43
    s_mov_b32 s66, 11403264
    s_mov_b32 s67, 0x20000
    v_lshrrev_b32 v8, 3, v1
    v_and_b32 v9, 7, v1
    v_bfe_u32 v10, v1, 4, 1
    v_lshlrev_b32 v10, 2, v10
    v_xor_b32 v10, v10, v9
    s_lshl_b32 s79, s73, 5
    v_add_u32 v11, s79, v8
    v_lshlrev_b32 v11, 10, v11
    v_lshl_add_u32 v11, v10, 4, v11
    s_lshl_b32 s79, s77, 7
    v_add_u32 v24, s79, v11
    v_add_u32 v25, 7168, v24
    v_add_u32 v26, 14336, v24
    v_add_u32 v27, 21504, v24
    s_waitcnt vmcnt(12)
    s_barrier
    s_add_u32 m0, s85, 49152
    s_add_u32 s82, s93, 0
    buffer_load_dwordx4 v36, s[56:59], s82 offen offset:0 lds
    s_add_u32 m0, m0, 960
    s_nop 0
    buffer_load_dwordx4 v36, s[56:59], s82 offen offset:64 lds
    s_add_u32 m0, m0, 960
    s_nop 0
    buffer_load_dwordx4 v36, s[56:59], s82 offen offset:128 lds
    s_add_u32 m0, s85, 52224
    s_add_u32 s82, s93, 44032
    buffer_load_dwordx4 v36, s[56:59], s82 offen offset:0 lds
    s_add_u32 m0, m0, 960
    s_nop 0
    buffer_load_dwordx4 v36, s[56:59], s82 offen offset:64 lds
    s_add_u32 m0, m0, 960
    s_nop 0
    buffer_load_dwordx4 v36, s[56:59], s82 offen offset:128 lds
    s_add_u32 m0, s85, 55296
    s_add_u32 s82, s93, 88064
    buffer_load_dwordx4 v36, s[56:59], s82 offen offset:0 lds
    s_add_u32 m0, m0, 960
    s_nop 0
    buffer_load_dwordx4 v36, s[56:59], s82 offen offset:64 lds
    s_add_u32 m0, m0, 960
    s_nop 0
    buffer_load_dwordx4 v36, s[56:59], s82 offen offset:128 lds
    s_add_u32 m0, s85, 58368
    s_add_u32 s82, s93, 132096
    buffer_load_dwordx4 v36, s[56:59], s82 offen offset:0 lds
    s_add_u32 m0, m0, 960
    s_nop 0
    buffer_load_dwordx4 v36, s[56:59], s82 offen offset:64 lds
    s_add_u32 m0, m0, 960
    s_nop 0
    buffer_load_dwordx4 v36, s[56:59], s82 offen offset:128 lds
    s_add_u32 s92, s100, 2
    s_and_b32 s92, s92, 7
    s_mul_i32 s93, s92, 176128
    s_lshl_b32 s92, s92, 7
    s_add_u32 s82, s92, 32768
    s_add_u32 m0, s83, 98304
    s_nop 0
    buffer_load_dwordx4 v28, s[48:51], s92 offen offset:0 lds
    buffer_load_dwordx4 v29, s[48:51], s92 offen offset:1024 lds
    buffer_load_dwordx4 v30, s[48:51], s92 offen offset:2048 lds
    buffer_load_dwordx4 v31, s[48:51], s92 offen offset:3072 lds
    s_add_u32 m0, s83, 102400
    s_nop 0
    buffer_load_dwordx4 v28, s[48:51], s82 offen offset:0 lds
    buffer_load_dwordx4 v29, s[48:51], s82 offen offset:1024 lds
    buffer_load_dwordx4 v30, s[48:51], s82 offen offset:2048 lds
    buffer_load_dwordx4 v31, s[48:51], s82 offen offset:3072 lds
    s_add_u32 m0, s84, 98304
    s_nop 0
    buffer_load_dwordx4 v32, s[52:55], s92 offen offset:0 lds
    buffer_load_dwordx4 v33, s[52:55], s92 offen offset:1024 lds
    buffer_load_dwordx4 v34, s[52:55], s92 offen offset:2048 lds
    buffer_load_dwordx4 v35, s[52:55], s92 offen offset:3072 lds
    s_add_u32 m0, s85, 98304
    s_add_u32 s82, s93, 0
    buffer_load_dwordx4 v36, s[56:59], s82 offen offset:0 lds
    s_add_u32 m0, m0, 960
    s_nop 0
    buffer_load_dwordx4 v36, s[56:59], s82 offen offset:64 lds
    s_add_u32 m0, m0, 960
    s_nop 0
    buffer_load_dwordx4 v36, s[56:59], s82 offen offset:128 lds
    s_add_u32 m0, s85, 101376
    s_add_u32 s82, s93, 44032
    buffer_load_dwordx4 v36, s[56:59], s82 offen offset:0 lds
    s_add_u32 m0, m0, 960
    s_nop 0
    buffer_load_dwordx4 v36, s[56:59], s82 offen offset:64 lds
    s_add_u32 m0, m0, 960
    s_nop 0
    buffer_load_dwordx4 v36, s[56:59], s82 offen offset:128 lds
    s_add_u32 m0, s85, 104448
    s_add_u32 s82, s93, 88064
    buffer_load_dwordx4 v36, s[56:59], s82 offen offset:0 lds
    s_add_u32 m0, m0, 960
    s_nop 0
    buffer_load_dwordx4 v36, s[56:59], s82 offen offset:64 lds
    s_add_u32 m0, m0, 960
    s_nop 0
    buffer_load_dwordx4 v36, s[56:59], s82 offen offset:128 lds
    s_add_u32 m0, s85, 107520
    s_add_u32 s82, s93, 132096
    buffer_load_dwordx4 v36, s[56:59], s82 offen offset:0 lds
    s_add_u32 m0, m0, 960
    s_nop 0
    buffer_load_dwordx4 v36, s[56:59], s82 offen offset:64 lds
    s_add_u32 m0, m0, 960
    s_nop 0
    buffer_load_dwordx4 v36, s[56:59], s82 offen offset:128 lds
    s_waitcnt vmcnt(24)
    s_barrier
    s_add_u32 s92, s100, 3
    s_and_b32 s92, s92, 7
    s_mul_i32 s93, s92, 176128
    s_lshl_b32 s92, s92, 7
    s_add_u32 s82, s92, 32768
    s_add_u32 m0, s83, 0
    s_nop 0
    buffer_load_dwordx4 v28, s[48:51], s92 offen offset:0 lds
    buffer_load_dwordx4 v29, s[48:51], s92 offen offset:1024 lds
    buffer_load_dwordx4 v30, s[48:51], s92 offen offset:2048 lds
    buffer_load_dwordx4 v31, s[48:51], s92 offen offset:3072 lds
    s_add_u32 m0, s83, 4096
    s_nop 0
    buffer_load_dwordx4 v28, s[48:51], s82 offen offset:0 lds
    buffer_load_dwordx4 v29, s[48:51], s82 offen offset:1024 lds
    buffer_load_dwordx4 v30, s[48:51], s82 offen offset:2048 lds
    buffer_load_dwordx4 v31, s[48:51], s82 offen offset:3072 lds
    s_add_u32 m0, s84, 0
    s_nop 0
    buffer_load_dwordx4 v32, s[52:55], s92 offen offset:0 lds
    buffer_load_dwordx4 v33, s[52:55], s92 offen offset:1024 lds
    buffer_load_dwordx4 v34, s[52:55], s92 offen offset:2048 lds
    buffer_load_dwordx4 v35, s[52:55], s92 offen offset:3072 lds
    s_add_u32 m0, s85, 0
    s_add_u32 s82, s93, 0
    buffer_load_dwordx4 v36, s[56:59], s82 offen offset:0 lds
    s_add_u32 m0, m0, 960
    s_nop 0
    buffer_load_dwordx4 v36, s[56:59], s82 offen offset:64 lds
    s_add_u32 m0, m0, 960
    s_nop 0
    buffer_load_dwordx4 v36, s[56:59], s82 offen offset:128 lds
    s_add_u32 m0, s85, 3072
    s_add_u32 s82, s93, 44032
    buffer_load_dwordx4 v36, s[56:59], s82 offen offset:0 lds
    s_add_u32 m0, m0, 960
    s_nop 0
    buffer_load_dwordx4 v36, s[56:59], s82 offen offset:64 lds
    s_add_u32 m0, m0, 960
    s_nop 0
    buffer_load_dwordx4 v36, s[56:59], s82 offen offset:128 lds
    s_add_u32 m0, s85, 6144
    s_add_u32 s82, s93, 88064
    buffer_load_dwordx4 v36, s[56:59], s82 offen offset:0 lds
    s_add_u32 m0, m0, 960
    s_nop 0
    buffer_load_dwordx4 v36, s[56:59], s82 offen offset:64 lds
    s_add_u32 m0, m0, 960
    s_nop 0
    buffer_load_dwordx4 v36, s[56:59], s82 offen offset:128 lds
    s_add_u32 m0, s85, 9216
    s_add_u32 s82, s93, 132096
    buffer_load_dwordx4 v36, s[56:59], s82 offen offset:0 lds
    s_add_u32 m0, m0, 960
    s_nop 0
    buffer_load_dwordx4 v36, s[56:59], s82 offen offset:64 lds
    s_add_u32 m0, m0, 960
    s_nop 0
    buffer_load_dwordx4 v36, s[56:59], s82 offen offset:128 lds
    s_waitcnt vmcnt(24)
    s_barrier
    s_add_u32 s92, s100, 4
    s_and_b32 s92, s92, 7
    s_mul_i32 s93, s92, 176128
    s_lshl_b32 s92, s92, 7
    s_add_u32 s82, s92, 32768
    s_add_u32 m0, s83, 49152
    s_nop 0
    buffer_load_dwordx4 v28, s[48:51], s92 offen offset:0 lds
    buffer_load_dwordx4 v29, s[48:51], s92 offen offset:1024 lds
    buffer_load_dwordx4 v30, s[48:51], s92 offen offset:2048 lds
    buffer_load_dwordx4 v31, s[48:51], s92 offen offset:3072 lds
    s_add_u32 m0, s83, 53248
    s_nop 0
    buffer_load_dwordx4 v28, s[48:51], s82 offen offset:0 lds
    buffer_load_dwordx4 v29, s[48:51], s82 offen offset:1024 lds
    buffer_load_dwordx4 v30, s[48:51], s82 offen offset:2048 lds
    buffer_load_dwordx4 v31, s[48:51], s82 offen offset:3072 lds
    s_add_u32 m0, s84, 49152
    s_nop 0
    buffer_load_dwordx4 v32, s[52:55], s92 offen offset:0 lds
    buffer_load_dwordx4 v33, s[52:55], s92 offen offset:1024 lds
    buffer_load_dwordx4 v34, s[52:55], s92 offen offset:2048 lds
    buffer_load_dwordx4 v35, s[52:55], s92 offen offset:3072 lds
    s_add_u32 m0, s85, 49152
    s_add_u32 s82, s93, 0
    buffer_load_dwordx4 v36, s[56:59], s82 offen offset:0 lds
    s_add_u32 m0, m0, 960
    s_nop 0
    buffer_load_dwordx4 v36, s[56:59], s82 offen offset:64 lds
    s_add_u32 m0, m0, 960
    s_nop 0
    buffer_load_dwordx4 v36, s[56:59], s82 offen offset:128 lds
    s_add_u32 m0, s85, 52224
    s_add_u32 s82, s93, 44032
    buffer_load_dwordx4 v36, s[56:59], s82 offen offset:0 lds
    s_add_u32 m0, m0, 960
    s_nop 0
    buffer_load_dwordx4 v36, s[56:59], s82 offen offset:64 lds
    s_add_u32 m0, m0, 960
    s_nop 0
    buffer_load_dwordx4 v36, s[56:59], s82 offen offset:128 lds
    s_add_u32 m0, s85, 55296
    s_add_u32 s82, s93, 88064
    buffer_load_dwordx4 v36, s[56:59], s82 offen offset:0 lds
    s_add_u32 m0, m0, 960
    s_nop 0
    buffer_load_dwordx4 v36, s[56:59], s82 offen offset:64 lds
    s_add_u32 m0, m0, 960
    s_nop 0
    buffer_load_dwordx4 v36, s[56:59], s82 offen offset:128 lds
    s_add_u32 m0, s85, 58368
    s_add_u32 s82, s93, 132096
    buffer_load_dwordx4 v36, s[56:59], s82 offen offset:0 lds
    s_add_u32 m0, m0, 960
    s_nop 0
    buffer_load_dwordx4 v36, s[56:59], s82 offen offset:64 lds
    s_add_u32 m0, m0, 960
    s_nop 0
    buffer_load_dwordx4 v36, s[56:59], s82 offen offset:128 lds
    s_waitcnt vmcnt(24)
    s_barrier
    s_add_u32 s92, s100, 5
    s_and_b32 s92, s92, 7
    s_mul_i32 s93, s92, 176128
    s_lshl_b32 s92, s92, 7
    s_add_u32 s82, s92, 32768
    s_add_u32 m0, s83, 98304
    s_nop 0
    buffer_load_dwordx4 v28, s[48:51], s92 offen offset:0 lds
    buffer_load_dwordx4 v29, s[48:51], s92 offen offset:1024 lds
    buffer_load_dwordx4 v30, s[48:51], s92 offen offset:2048 lds
    buffer_load_dwordx4 v31, s[48:51], s92 offen offset:3072 lds
    s_add_u32 m0, s83, 102400
    s_nop 0
    buffer_load_dwordx4 v28, s[48:51], s82 offen offset:0 lds
    buffer_load_dwordx4 v29, s[48:51], s82 offen offset:1024 lds
    buffer_load_dwordx4 v30, s[48:51], s82 offen offset:2048 lds
    buffer_load_dwordx4 v31, s[48:51], s82 offen offset:3072 lds
    s_add_u32 m0, s84, 98304
    s_nop 0
    buffer_load_dwordx4 v32, s[52:55], s92 offen offset:0 lds
    buffer_load_dwordx4 v33, s[52:55], s92 offen offset:1024 lds
    buffer_load_dwordx4 v34, s[52:55], s92 offen offset:2048 lds
    buffer_load_dwordx4 v35, s[52:55], s92 offen offset:3072 lds
    s_add_u32 m0, s85, 98304
    s_add_u32 s82, s93, 0
    buffer_load_dwordx4 v36, s[56:59], s82 offen offset:0 lds
    s_add_u32 m0, m0, 960
    s_nop 0
    buffer_load_dwordx4 v36, s[56:59], s82 offen offset:64 lds
    s_add_u32 m0, m0, 960
    s_nop 0
    buffer_load_dwordx4 v36, s[56:59], s82 offen offset:128 lds
    s_add_u32 m0, s85, 101376
    s_add_u32 s82, s93, 44032
    buffer_load_dwordx4 v36, s[56:59], s82 offen offset:0 lds
    s_add_u32 m0, m0, 960
    s_nop 0
    buffer_load_dwordx4 v36, s[56:59], s82 offen offset:64 lds
    s_add_u32 m0, m0, 960
    s_nop 0
    buffer_load_dwordx4 v36, s[56:59], s82 offen offset:128 lds
    s_add_u32 m0, s85, 104448
    s_add_u32 s82, s93, 88064
    buffer_load_dwordx4 v36, s[56:59], s82 offen offset:0 lds
    s_add_u32 m0, m0, 960
    s_nop 0
    buffer_load_dwordx4 v36, s[56:59], s82 offen offset:64 lds
    s_add_u32 m0, m0, 960
    s_nop 0
    buffer_load_dwordx4 v36, s[56:59], s82 offen offset:128 lds
    s_add_u32 m0, s85, 107520
    s_add_u32 s82, s93, 132096
    buffer_load_dwordx4 v36, s[56:59], s82 offen offset:0 lds
    s_add_u32 m0, m0, 960
    s_nop 0
    buffer_load_dwordx4 v36, s[56:59], s82 offen offset:64 lds
    s_add_u32 m0, m0, 960
    s_nop 0
    buffer_load_dwordx4 v36, s[56:59], s82 offen offset:128 lds
    s_waitcnt vmcnt(24)
    s_barrier
    s_add_u32 s92, s100, 6
    s_and_b32 s92, s92, 7
    s_mul_i32 s93, s92, 176128
    s_lshl_b32 s92, s92, 7
    s_add_u32 s82, s92, 32768
    s_add_u32 m0, s83, 0
    s_nop 0
    buffer_load_dwordx4 v28, s[48:51], s92 offen offset:0 lds
    buffer_load_dwordx4 v29, s[48:51], s92 offen offset:1024 lds
    buffer_load_dwordx4 v30, s[48:51], s92 offen offset:2048 lds
    buffer_load_dwordx4 v31, s[48:51], s92 offen offset:3072 lds
    s_add_u32 m0, s83, 4096
    s_nop 0
    buffer_load_dwordx4 v28, s[48:51], s82 offen offset:0 lds
    buffer_load_dwordx4 v29, s[48:51], s82 offen offset:1024 lds
    buffer_load_dwordx4 v30, s[48:51], s82 offen offset:2048 lds
    buffer_load_dwordx4 v31, s[48:51], s82 offen offset:3072 lds
    s_add_u32 m0, s84, 0
    s_nop 0
    buffer_load_dwordx4 v32, s[52:55], s92 offen offset:0 lds
    buffer_load_dwordx4 v33, s[52:55], s92 offen offset:1024 lds
    buffer_load_dwordx4 v34, s[52:55], s92 offen offset:2048 lds
    buffer_load_dwordx4 v35, s[52:55], s92 offen offset:3072 lds
    s_add_u32 m0, s85, 0
    s_add_u32 s82, s93, 0
    buffer_load_dwordx4 v36, s[56:59], s82 offen offset:0 lds
    s_add_u32 m0, m0, 960
    s_nop 0
    buffer_load_dwordx4 v36, s[56:59], s82 offen offset:64 lds
    s_add_u32 m0, m0, 960
    s_nop 0
    buffer_load_dwordx4 v36, s[56:59], s82 offen offset:128 lds
    s_add_u32 m0, s85, 3072
    s_add_u32 s82, s93, 44032
    buffer_load_dwordx4 v36, s[56:59], s82 offen offset:0 lds
    s_add_u32 m0, m0, 960
    s_nop 0
    buffer_load_dwordx4 v36, s[56:59], s82 offen offset:64 lds
    s_add_u32 m0, m0, 960
    s_nop 0
    buffer_load_dwordx4 v36, s[56:59], s82 offen offset:128 lds
    s_add_u32 m0, s85, 6144
    s_add_u32 s82, s93, 88064
    buffer_load_dwordx4 v36, s[56:59], s82 offen offset:0 lds
    s_add_u32 m0, m0, 960
    s_nop 0
    buffer_load_dwordx4 v36, s[56:59], s82 offen offset:64 lds
    s_add_u32 m0, m0, 960
    s_nop 0
    buffer_load_dwordx4 v36, s[56:59], s82 offen offset:128 lds
    s_add_u32 m0, s85, 9216
    s_add_u32 s82, s93, 132096
    buffer_load_dwordx4 v36, s[56:59], s82 offen offset:0 lds
    s_add_u32 m0, m0, 960
    s_nop 0
    buffer_load_dwordx4 v36, s[56:59], s82 offen offset:64 lds
    s_add_u32 m0, m0, 960
    s_nop 0
    buffer_load_dwordx4 v36, s[56:59], s82 offen offset:128 lds
    s_waitcnt vmcnt(24)
    s_barrier
    s_add_u32 s92, s100, 7
    s_and_b32 s92, s92, 7
    s_mul_i32 s93, s92, 176128
    s_lshl_b32 s92, s92, 7
    s_add_u32 s82, s92, 32768
    s_add_u32 m0, s83, 49152
    s_nop 0
    buffer_load_dwordx4 v28, s[48:51], s92 offen offset:0 lds
    buffer_load_dwordx4 v29, s[48:51], s92 offen offset:1024 lds
    buffer_load_dwordx4 v30, s[48:51], s92 offen offset:2048 lds
    buffer_load_dwordx4 v31, s[48:51], s92 offen offset:3072 lds
    s_add_u32 m0, s83, 53248
    s_nop 0
    buffer_load_dwordx4 v28, s[48:51], s82 offen offset:0 lds
    buffer_load_dwordx4 v29, s[48:51], s82 offen offset:1024 lds
    buffer_load_dwordx4 v30, s[48:51], s82 offen offset:2048 lds
    buffer_load_dwordx4 v31, s[48:51], s82 offen offset:3072 lds
    s_add_u32 m0, s84, 49152
    s_nop 0
    buffer_load_dwordx4 v32, s[52:55], s92 offen offset:0 lds
    buffer_load_dwordx4 v33, s[52:55], s92 offen offset:1024 lds
    buffer_load_dwordx4 v34, s[52:55], s92 offen offset:2048 lds
    buffer_load_dwordx4 v35, s[52:55], s92 offen offset:3072 lds
    s_add_u32 m0, s85, 49152
    s_add_u32 s82, s93, 0
    buffer_load_dwordx4 v36, s[56:59], s82 offen offset:0 lds
    s_add_u32 m0, m0, 960
    s_nop 0
    buffer_load_dwordx4 v36, s[56:59], s82 offen offset:64 lds
    s_add_u32 m0, m0, 960
    s_nop 0
    buffer_load_dwordx4 v36, s[56:59], s82 offen offset:128 lds
    s_add_u32 m0, s85, 52224
    s_add_u32 s82, s93, 44032
    buffer_load_dwordx4 v36, s[56:59], s82 offen offset:0 lds
    s_add_u32 m0, m0, 960
    s_nop 0
    buffer_load_dwordx4 v36, s[56:59], s82 offen offset:64 lds
    s_add_u32 m0, m0, 960
    s_nop 0
    buffer_load_dwordx4 v36, s[56:59], s82 offen offset:128 lds
    s_add_u32 m0, s85, 55296
    s_add_u32 s82, s93, 88064
    buffer_load_dwordx4 v36, s[56:59], s82 offen offset:0 lds
    s_add_u32 m0, m0, 960
    s_nop 0
    buffer_load_dwordx4 v36, s[56:59], s82 offen offset:64 lds
    s_add_u32 m0, m0, 960
    s_nop 0
    buffer_load_dwordx4 v36, s[56:59], s82 offen offset:128 lds
    s_add_u32 m0, s85, 58368
    s_add_u32 s82, s93, 132096
    buffer_load_dwordx4 v36, s[56:59], s82 offen offset:0 lds
    s_add_u32 m0, m0, 960
    s_nop 0
    buffer_load_dwordx4 v36, s[56:59], s82 offen offset:64 lds
    s_add_u32 m0, m0, 960
    s_nop 0
    buffer_load_dwordx4 v36, s[56:59], s82 offen offset:128 lds
    global_load_dwordx2 v[38:39], v4, s[40:41] sc0 sc1
    s_waitcnt vmcnt(25)
    s_barrier
    s_add_u32 m0, s86, 98304
    s_mov_b32 s82, 0
    buffer_load_dwordx4 v24, s[68:71], s82 offen offset:0 lds
    buffer_load_dwordx4 v25, s[68:71], s82 offen offset:1024 lds
    buffer_load_dwordx4 v26, s[68:71], s82 offen offset:2048 lds
    buffer_load_dwordx4 v27, s[68:71], s82 offen offset:3072 lds
    s_add_u32 m0, s86, 106496
    s_mov_b32 s82, 65536
    buffer_load_dwordx4 v24, s[68:71], s82 offen offset:0 lds
    buffer_load_dwordx4 v25, s[68:71], s82 offen offset:1024 lds
    buffer_load_dwordx4 v26, s[68:71], s82 offen offset:2048 lds
    buffer_load_dwordx4 v27, s[68:71], s82 offen offset:3072 lds
    s_add_u32 m0, s86, 114688
    s_mov_b32 s82, 131072
    buffer_load_dwordx4 v24, s[68:71], s82 offen offset:0 lds
    buffer_load_dwordx4 v25, s[68:71], s82 offen offset:1024 lds
    buffer_load_dwordx4 v26, s[68:71], s82 offen offset:2048 lds
    buffer_load_dwordx4 v27, s[68:71], s82 offen offset:3072 lds
    s_add_u32 m0, s86, 122880
    s_mov_b32 s82, 196608
    buffer_load_dwordx4 v24, s[68:71], s82 offen offset:0 lds
    buffer_load_dwordx4 v25, s[68:71], s82 offen offset:1024 lds
    buffer_load_dwordx4 v26, s[68:71], s82 offen offset:2048 lds
    buffer_load_dwordx4 v27, s[68:71], s82 offen offset:3072 lds
    s_add_u32 m0, s86, 131072
    s_mov_b32 s82, 262144
    buffer_load_dwordx4 v24, s[68:71], s82 offen offset:0 lds
    buffer_load_dwordx4 v25, s[68:71], s82 offen offset:1024 lds
    buffer_load_dwordx4 v26, s[68:71], s82 offen offset:2048 lds
    buffer_load_dwordx4 v27, s[68:71], s82 offen offset:3072 lds
    s_add_u32 m0, s86, 139264
    s_mov_b32 s82, 327680
    buffer_load_dwordx4 v24, s[68:71], s82 offen offset:0 lds
    buffer_load_dwordx4 v25, s[68:71], s82 offen offset:1024 lds
    buffer_load_dwordx4 v26, s[68:71], s82 offen offset:2048 lds
    buffer_load_dwordx4 v27, s[68:71], s82 offen offset:3072 lds
    s_waitcnt vmcnt(25)
    s_barrier
    s_add_u32 m0, s86, 0
    s_mov_b32 s82, 393216
    buffer_load_dwordx4 v24, s[68:71], s82 offen offset:0 lds
    buffer_load_dwordx4 v25, s[68:71], s82 offen offset:1024 lds
    buffer_load_dwordx4 v26, s[68:71], s82 offen offset:2048 lds
    buffer_load_dwordx4 v27, s[68:71], s82 offen offset:3072 lds
    s_add_u32 m0, s86, 8192
    s_mov_b32 s82, 458752
    buffer_load_dwordx4 v24, s[68:71], s82 offen offset:0 lds
    buffer_load_dwordx4 v25, s[68:71], s82 offen offset:1024 lds
    buffer_load_dwordx4 v26, s[68:71], s82 offen offset:2048 lds
    buffer_load_dwordx4 v27, s[68:71], s82 offen offset:3072 lds
    s_add_u32 m0, s86, 16384
    s_mov_b32 s82, 524288
    buffer_load_dwordx4 v24, s[68:71], s82 offen offset:0 lds
    buffer_load_dwordx4 v25, s[68:71], s82 offen offset:1024 lds
    buffer_load_dwordx4 v26, s[68:71], s82 offen offset:2048 lds
    buffer_load_dwordx4 v27, s[68:71], s82 offen offset:3072 lds
    s_add_u32 m0, s86, 24576
    s_mov_b32 s82, 589824
    buffer_load_dwordx4 v24, s[68:71], s82 offen offset:0 lds
    buffer_load_dwordx4 v25, s[68:71], s82 offen offset:1024 lds
    buffer_load_dwordx4 v26, s[68:71], s82 offen offset:2048 lds
    buffer_load_dwordx4 v27, s[68:71], s82 offen offset:3072 lds
    s_add_u32 m0, s86, 32768
    s_mov_b32 s82, 655360
    buffer_load_dwordx4 v24, s[68:71], s82 offen offset:0 lds
    buffer_load_dwordx4 v25, s[68:71], s82 offen offset:1024 lds
    buffer_load_dwordx4 v26, s[68:71], s82 offen offset:2048 lds
    buffer_load_dwordx4 v27, s[68:71], s82 offen offset:3072 lds
    s_add_u32 m0, s86, 40960
    s_mov_b32 s82, 720896
    buffer_load_dwordx4 v24, s[68:71], s82 offen offset:0 lds
    buffer_load_dwordx4 v25, s[68:71], s82 offen offset:1024 lds
    buffer_load_dwordx4 v26, s[68:71], s82 offen offset:2048 lds
    buffer_load_dwordx4 v27, s[68:71], s82 offen offset:3072 lds
    s_barrier
    s_waitcnt vmcnt(48)
    v_readfirstlane_b32 s46, v38
    v_readfirstlane_b32 s47, v39
    s_cmp_lg_u32 s46, 0
    s_cbranch_scc1 L_ln_ok
L_ln_retry:
    s_add_u32 s3, s3, 1
    s_cmp_gt_u32 s3, 1048576
    s_cbranch_scc1 L_ln_ok
    global_load_dwordx2 v[38:39], v4, s[40:41] sc0 sc1
    s_waitcnt vmcnt(0)
    v_readfirstlane_b32 s46, v38
    v_readfirstlane_b32 s47, v39
    s_nop 1
    s_cmp_lg_u32 s46, 0
    s_cbranch_scc0 L_ln_retry
L_ln_ok:
    s_nop 4
    s_waitcnt vmcnt(0)
    s_branch L_p2
L_wrk:
    s_and_b32 s83, s73, 1
    s_and_b32 s84, s74, 7
    v_bfe_u32 v8, v1, 2, 2
    v_lshl_add_u32 v8, v2, 3, v8
    v_lshlrev_b32 v8, 6, v8
    v_bfe_u32 v9, v1, 4, 1
    v_lshl_add_u32 v8, v9, 5, v8
    v_and_b32 v9, 3, v1
    v_lshl_add_u32 v6, v9, 3, v8
    s_mov_b32 s87, 0x3f803f80
    s_and_b32 s79, s75, 3
    s_lshl_b32 s79, s79, 12
    s_lshl_b32 s80, s84, 12
    s_add_u32 s80, s80, 16384
    s_cmp_eq_u32 s83, 0
    s_cselect_b32 s79, s79, s80
    v_and_b32 v8, 31, v1
    v_bfe_u32 v9, v8, 1, 3
    v_xor_b32 v9, v9, v2
    v_lshl_add_u32 v8, v8, 7, s79
    v_xor_b32 v11, 0, v9
    v_lshl_add_u32 v30, v11, 4, v8
    v_xor_b32 v11, 2, v9
    v_lshl_add_u32 v31, v11, 4, v8
    v_xor_b32 v11, 4, v9
    v_lshl_add_u32 v32, v11, 4, v8
    v_xor_b32 v11, 6, v9
    v_lshl_add_u32 v33, v11, 4, v8
    s_sub_u32 s79, s84, 2
    s_and_b32 s80, s79, 1
    s_mul_i32 s80, s80, 12
    s_lshr_b32 s79, s79, 1
    s_and_b32 s79, s79, 3
    s_add_u32 s79, s79, s80
    s_lshl_b32 s79, s79, 10
    s_add_u32 s79, s79, 24576
    v_add_u32 v88, s79, v6
    v_mov_b32 v36, 0
    v_mov_b32 v37, 0
    v_mov_b32 v38, 0
    v_mov_b32 v39, 0
    s_cmp_lt_u32 s84, 2
    s_cselect_b32 s86, 1, 2
    s_cmp_eq_u32 s83, 0
    s_cselect_b32 s86, 0, s86
    s_waitcnt lgkmcnt(0)
    s_mov_b32 s48, s16
    s_mov_b32 s49, s17
    s_mov_b32 s50, 2097152
    s_mov_b32 s51, 0x20000
    s_mov_b32 s52, s22
    s_mov_b32 s53, s23
    s_mov_b32 s54, 524288
    s_mov_b32 s55, 0x20000
    s_mov_b32 s8, s24
    s_mov_b32 s9, s25
    s_mov_b32 s10, 524288
    s_mov_b32 s11, 0x20000
    s_mov_b32 s56, s32
    s_mov_b32 s57, s33
    s_mov_b32 s58, 1409024
    s_mov_b32 s59, 0x20000
    s_mov_b32 s60, s34
    s_mov_b32 s61, s35
    s_mov_b32 s62, 1409024
    s_mov_b32 s63, 0x20000
    s_mov_b32 s64, s42
    s_mov_b32 s65, s43
    s_mov_b32 s66, 11403264
    s_mov_b32 s67, 0x20000
    s_mov_b32 s68, s36
    s_mov_b32 s69, s37
    s_mov_b32 s70, 1409024
    s_mov_b32 s71, 0x20000
    s_barrier
    s_cmp_eq_u32 s86, 2
    s_cbranch_scc1 L_pt0_g
    v_add_u32 v8, 0, v30
    ds_read_b128 v[40:43], v8
    v_add_u32 v9, 0, v31
    ds_read_b128 v[44:47], v9
    v_add_u32 v10, 0, v32
    ds_read_b128 v[48:51], v10
    v_add_u32 v11, 0, v33
    ds_read_b128 v[52:55], v11
    s_branch L_pt0_d
L_pt0_g:
    v_add_u32 v8, 0, v88
    s_waitcnt lgkmcnt(3)
    ds_read_b64_tr_b16 v[40:41], v8 offset:0
    ds_read_b64_tr_b16 v[42:43], v8 offset:256
    s_waitcnt lgkmcnt(4)
    ds_read_b64_tr_b16 v[44:45], v8 offset:3072
    ds_read_b64_tr_b16 v[46:47], v8 offset:3328
    s_waitcnt lgkmcnt(5)
    ds_read_b64_tr_b16 v[48:49], v8 offset:6144
    ds_read_b64_tr_b16 v[50:51], v8 offset:6400
    s_waitcnt lgkmcnt(6)
    ds_read_b64_tr_b16 v[52:53], v8 offset:9216
    ds_read_b64_tr_b16 v[54:55], v8 offset:9472
L_pt0_d:
    s_waitcnt lgkmcnt(0)
    v_lshlrev_b32 v56, 16, v40
    v_and_b32 v72, 0xffff0000, v40
    v_lshlrev_b32 v57, 16, v41
    v_and_b32 v73, 0xffff0000, v41
    v_lshlrev_b32 v58, 16, v42
    v_and_b32 v74, 0xffff0000, v42
    v_lshlrev_b32 v59, 16, v43
    v_and_b32 v75, 0xffff0000, v43
    v_lshlrev_b32 v60, 16, v44
    v_and_b32 v76, 0xffff0000, v44
    v_lshlrev_b32 v61, 16, v45
    v_and_b32 v77, 0xffff0000, v45
    v_lshlrev_b32 v62, 16, v46
    v_and_b32 v78, 0xffff0000, v46
    v_lshlrev_b32 v63, 16, v47
    v_and_b32 v79, 0xffff0000, v47
    v_lshlrev_b32 v64, 16, v48
    v_and_b32 v80, 0xffff0000, v48
    v_lshlrev_b32 v65, 16, v49
    v_and_b32 v81, 0xffff0000, v49
    v_lshlrev_b32 v66, 16, v50
    v_and_b32 v82, 0xffff0000, v50
    v_lshlrev_b32 v67, 16, v51
    v_and_b32 v83, 0xffff0000, v51
    v_lshlrev_b32 v68, 16, v52
    v_and_b32 v84, 0xffff0000, v52
    v_lshlrev_b32 v69, 16, v53
    v_and_b32 v85, 0xffff0000, v53
    v_lshlrev_b32 v70, 16, v54
    v_and_b32 v86, 0xffff0000, v54
    v_lshlrev_b32 v71, 16, v55
    v_and_b32 v87, 0xffff0000, v55
    v_add_f32 v36, v36, v56
    v_add_f32 v38, v38, v72
    v_add_f32 v36, v36, v57
    v_add_f32 v38, v38, v73
    v_add_f32 v36, v36, v58
    v_add_f32 v38, v38, v74
    v_add_f32 v36, v36, v59
    v_add_f32 v38, v38, v75
    v_add_f32 v36, v36, v60
    v_add_f32 v38, v38, v76
    v_add_f32 v36, v36, v61
    v_add_f32 v38, v38, v77
    v_add_f32 v36, v36, v62
    v_add_f32 v38, v38, v78
    v_add_f32 v36, v36, v63
    v_add_f32 v38, v38, v79
    v_add_f32 v36, v36, v64
    v_add_f32 v38, v38, v80
    v_add_f32 v36, v36, v65
    v_add_f32 v38, v38, v81
    v_add_f32 v36, v36, v66
    v_add_f32 v38, v38, v82
    v_add_f32 v36, v36, v67
    v_add_f32 v38, v38, v83
    v_add_f32 v36, v36, v68
    v_add_f32 v38, v38, v84
    v_add_f32 v36, v36, v69
    v_add_f32 v38, v38, v85
    v_add_f32 v36, v36, v70
    v_add_f32 v38, v38, v86
    v_add_f32 v36, v36, v71
    v_add_f32 v38, v38, v87
    s_cmp_eq_u32 s86, 0
    s_cbranch_scc0 L_pt0_e
    v_fma_f32 v37, v56, v56, v37
    v_fma_f32 v39, v72, v72, v39
    v_fma_f32 v37, v57, v57, v37
    v_fma_f32 v39, v73, v73, v39
    v_fma_f32 v37, v58, v58, v37
    v_fma_f32 v39, v74, v74, v39
    v_fma_f32 v37, v59, v59, v37
    v_fma_f32 v39, v75, v75, v39
    v_fma_f32 v37, v60, v60, v37
    v_fma_f32 v39, v76, v76, v39
    v_fma_f32 v37, v61, v61, v37
    v_fma_f32 v39, v77, v77, v39
    v_fma_f32 v37, v62, v62, v37
    v_fma_f32 v39, v78, v78, v39
    v_fma_f32 v37, v63, v63, v37
    v_fma_f32 v39, v79, v79, v39
    v_fma_f32 v37, v64, v64, v37
    v_fma_f32 v39, v80, v80, v39
    v_fma_f32 v37, v65, v65, v37
    v_fma_f32 v39, v81, v81, v39
    v_fma_f32 v37, v66, v66, v37
    v_fma_f32 v39, v82, v82, v39
    v_fma_f32 v37, v67, v67, v37
    v_fma_f32 v39, v83, v83, v39
    v_fma_f32 v37, v68, v68, v37
    v_fma_f32 v39, v84, v84, v39
    v_fma_f32 v37, v69, v69, v37
    v_fma_f32 v39, v85, v85, v39
    v_fma_f32 v37, v70, v70, v37
    v_fma_f32 v39, v86, v86, v39
    v_fma_f32 v37, v71, v71, v37
    v_fma_f32 v39, v87, v87, v39
L_pt0_e:
    s_nop 2
    s_barrier
    global_load_dwordx2 v[28:29], v4, s[40:41] sc0 sc1
    s_cmp_eq_u32 s86, 2
    s_cbranch_scc1 L_pt1_g
    v_add_u32 v8, 49152, v30
    ds_read_b128 v[40:43], v8
    v_add_u32 v9, 49152, v31
    ds_read_b128 v[44:47], v9
    v_add_u32 v10, 49152, v32
    ds_read_b128 v[48:51], v10
    v_add_u32 v11, 49152, v33
    ds_read_b128 v[52:55], v11
    s_branch L_pt1_d
L_pt1_g:
    v_add_u32 v8, 49152, v88
    s_waitcnt lgkmcnt(3)
    ds_read_b64_tr_b16 v[40:41], v8 offset:0
    ds_read_b64_tr_b16 v[42:43], v8 offset:256
    s_waitcnt lgkmcnt(4)
    ds_read_b64_tr_b16 v[44:45], v8 offset:3072
    ds_read_b64_tr_b16 v[46:47], v8 offset:3328
    s_waitcnt lgkmcnt(5)
    ds_read_b64_tr_b16 v[48:49], v8 offset:6144
    ds_read_b64_tr_b16 v[50:51], v8 offset:6400
    s_waitcnt lgkmcnt(6)
    ds_read_b64_tr_b16 v[52:53], v8 offset:9216
    ds_read_b64_tr_b16 v[54:55], v8 offset:9472
L_pt1_d:
    s_waitcnt lgkmcnt(0)
    v_lshlrev_b32 v56, 16, v40
    v_and_b32 v72, 0xffff0000, v40
    v_lshlrev_b32 v57, 16, v41
    v_and_b32 v73, 0xffff0000, v41
    v_lshlrev_b32 v58, 16, v42
    v_and_b32 v74, 0xffff0000, v42
    v_lshlrev_b32 v59, 16, v43
    v_and_b32 v75, 0xffff0000, v43
    v_lshlrev_b32 v60, 16, v44
    v_and_b32 v76, 0xffff0000, v44
    v_lshlrev_b32 v61, 16, v45
    v_and_b32 v77, 0xffff0000, v45
    v_lshlrev_b32 v62, 16, v46
    v_and_b32 v78, 0xffff0000, v46
    v_lshlrev_b32 v63, 16, v47
    v_and_b32 v79, 0xffff0000, v47
    v_lshlrev_b32 v64, 16, v48
    v_and_b32 v80, 0xffff0000, v48
    v_lshlrev_b32 v65, 16, v49
    v_and_b32 v81, 0xffff0000, v49
    v_lshlrev_b32 v66, 16, v50
    v_and_b32 v82, 0xffff0000, v50
    v_lshlrev_b32 v67, 16, v51
    v_and_b32 v83, 0xffff0000, v51
    v_lshlrev_b32 v68, 16, v52
    v_and_b32 v84, 0xffff0000, v52
    v_lshlrev_b32 v69, 16, v53
    v_and_b32 v85, 0xffff0000, v53
    v_lshlrev_b32 v70, 16, v54
    v_and_b32 v86, 0xffff0000, v54
    v_lshlrev_b32 v71, 16, v55
    v_and_b32 v87, 0xffff0000, v55
    v_add_f32 v36, v36, v56
    v_add_f32 v38, v38, v72
    v_add_f32 v36, v36, v57
    v_add_f32 v38, v38, v73
    v_add_f32 v36, v36, v58
    v_add_f32 v38, v38, v74
    v_add_f32 v36, v36, v59
    v_add_f32 v38, v38, v75
    v_add_f32 v36, v36, v60
    v_add_f32 v38, v38, v76
    v_add_f32 v36, v36, v61
    v_add_f32 v38, v38, v77
    v_add_f32 v36, v36, v62
    v_add_f32 v38, v38, v78
    v_add_f32 v36, v36, v63
    v_add_f32 v38, v38, v79
    v_add_f32 v36, v36, v64
    v_add_f32 v38, v38, v80
    v_add_f32 v36, v36, v65
    v_add_f32 v38, v38, v81
    v_add_f32 v36, v36, v66
    v_add_f32 v38, v38, v82
    v_add_f32 v36, v36, v67
    v_add_f32 v38, v38, v83
    v_add_f32 v36, v36, v68
    v_add_f32 v38, v38, v84
    v_add_f32 v36, v36, v69
    v_add_f32 v38, v38, v85
    v_add_f32 v36, v36, v70
    v_add_f32 v38, v38, v86
    v_add_f32 v36, v36, v71
    v_add_f32 v38, v38, v87
    s_cmp_eq_u32 s86, 0
    s_cbranch_scc0 L_pt1_e
    v_fma_f32 v37, v56, v56, v37
    v_fma_f32 v39, v72, v72, v39
    v_fma_f32 v37, v57, v57, v37
    v_fma_f32 v39, v73, v73, v39
    v_fma_f32 v37, v58, v58, v37
    v_fma_f32 v39, v74, v74, v39
    v_fma_f32 v37, v59, v59, v37
    v_fma_f32 v39, v75, v75, v39
    v_fma_f32 v37, v60, v60, v37
    v_fma_f32 v39, v76, v76, v39
    v_fma_f32 v37, v61, v61, v37
    v_fma_f32 v39, v77, v77, v39
    v_fma_f32 v37, v62, v62, v37
    v_fma_f32 v39, v78, v78, v39
    v_fma_f32 v37, v63, v63, v37
    v_fma_f32 v39, v79, v79, v39
    v_fma_f32 v37, v64, v64, v37
    v_fma_f32 v39, v80, v80, v39
    v_fma_f32 v37, v65, v65, v37
    v_fma_f32 v39, v81, v81, v39
    v_fma_f32 v37, v66, v66, v37
    v_fma_f32 v39, v82, v82, v39
    v_fma_f32 v37, v67, v67, v37
    v_fma_f32 v39, v83, v83, v39
    v_fma_f32 v37, v68, v68, v37
    v_fma_f32 v39, v84, v84, v39
    v_fma_f32 v37, v69, v69, v37
    v_fma_f32 v39, v85, v85, v39
    v_fma_f32 v37, v70, v70, v37
    v_fma_f32 v39, v86, v86, v39
    v_fma_f32 v37, v71, v71, v37
    v_fma_f32 v39, v87, v87, v39
L_pt1_e:
    s_nop 2
    s_waitcnt vmcnt(0)
    v_readfirstlane_b32 s46, v28
    v_readfirstlane_b32 s47, v29
    s_cmp_lg_u32 s46, 0
    s_cbranch_scc1 L_hn_ok
L_hn_retry:
    s_add_u32 s3, s3, 1
    s_cmp_gt_u32 s3, 1048576
    s_cbranch_scc1 L_hn_ok
    global_load_dwordx2 v[28:29], v4, s[40:41] sc0 sc1
    s_waitcnt vmcnt(0)
    v_readfirstlane_b32 s46, v28
    v_readfirstlane_b32 s47, v29
    s_nop 1
    s_cmp_lg_u32 s46, 0
    s_cbranch_scc0 L_hn_retry
L_hn_ok:
    s_nop 4
    s_cmp_eq_u32 s83, 0
    s_cbranch_scc0 L_pb0
    v_add_f32 v36, v36, v38
    v_add_f32 v37, v37, v39
    v_mov_b32 v8, v36
    v_mov_b32 v9, v37
    s_nop 0
    v_permlane32_swap_b32 v36, v8
    v_permlane32_swap_b32 v37, v9
    v_add_f32 v36, v36, v8
    v_add_f32 v37, v37, v9
    v_mov_b32 v38, s46
    v_mov_b32 v39, s47
    s_lshr_b32 s79, s75, 2
    s_lshl_b32 s79, s79, 15
    s_lshl_b32 s80, s74, 11
    s_add_u32 s79, s79, s80
    s_and_b32 s80, s75, 3
    s_lshl_b32 s80, s80, 9
    s_add_u32 s79, s79, s80
    s_add_u32 s79, s79, 10485760
    s_mov_b32 exec_hi, 0
    buffer_store_dwordx4 v[36:39], v5, s[64:67], s79 offen sc0 sc1
    s_mov_b64 exec, -1
L_pb0:
    s_barrier
    s_cmp_eq_u32 s86, 0
    s_cbranch_scc1 L_pt2_e
    s_cmp_eq_u32 s86, 2
    s_cbranch_scc1 L_pt2_g
    v_add_u32 v8, 98304, v30
    ds_read_b128 v[40:43], v8
    v_add_u32 v9, 98304, v31
    ds_read_b128 v[44:47], v9
    v_add_u32 v10, 98304, v32
    ds_read_b128 v[48:51], v10
    v_add_u32 v11, 98304, v33
    ds_read_b128 v[52:55], v11
    s_branch L_pt2_d
L_pt2_g:
    v_add_u32 v8, 98304, v88
    s_waitcnt lgkmcnt(3)
    ds_read_b64_tr_b16 v[40:41], v8 offset:0
    ds_read_b64_tr_b16 v[42:43], v8 offset:256
    s_waitcnt lgkmcnt(4)
    ds_read_b64_tr_b16 v[44:45], v8 offset:3072
    ds_read_b64_tr_b16 v[46:47], v8 offset:3328
    s_waitcnt lgkmcnt(5)
    ds_read_b64_tr_b16 v[48:49], v8 offset:6144
    ds_read_b64_tr_b16 v[50:51], v8 offset:6400
    s_waitcnt lgkmcnt(6)
    ds_read_b64_tr_b16 v[52:53], v8 offset:9216
    ds_read_b64_tr_b16 v[54:55], v8 offset:9472
L_pt2_d:
    s_waitcnt lgkmcnt(0)
    v_lshlrev_b32 v56, 16, v40
    v_and_b32 v72, 0xffff0000, v40
    v_lshlrev_b32 v57, 16, v41
    v_and_b32 v73, 0xffff0000, v41
    v_lshlrev_b32 v58, 16, v42
    v_and_b32 v74, 0xffff0000, v42
    v_lshlrev_b32 v59, 16, v43
    v_and_b32 v75, 0xffff0000, v43
    v_lshlrev_b32 v60, 16, v44
    v_and_b32 v76, 0xffff0000, v44
    v_lshlrev_b32 v61, 16, v45
    v_and_b32 v77, 0xffff0000, v45
    v_lshlrev_b32 v62, 16, v46
    v_and_b32 v78, 0xffff0000, v46
    v_lshlrev_b32 v63, 16, v47
    v_and_b32 v79, 0xffff0000, v47
    v_lshlrev_b32 v64, 16, v48
    v_and_b32 v80, 0xffff0000, v48
    v_lshlrev_b32 v65, 16, v49
    v_and_b32 v81, 0xffff0000, v49
    v_lshlrev_b32 v66, 16, v50
    v_and_b32 v82, 0xffff0000, v50
    v_lshlrev_b32 v67, 16, v51
    v_and_b32 v83, 0xffff0000, v51
    v_lshlrev_b32 v68, 16, v52
    v_and_b32 v84, 0xffff0000, v52
    v_lshlrev_b32 v69, 16, v53
    v_and_b32 v85, 0xffff0000, v53
    v_lshlrev_b32 v70, 16, v54
    v_and_b32 v86, 0xffff0000, v54
    v_lshlrev_b32 v71, 16, v55
    v_and_b32 v87, 0xffff0000, v55
    v_add_f32 v36, v36, v56
    v_add_f32 v38, v38, v72
    v_add_f32 v36, v36, v57
    v_add_f32 v38, v38, v73
    v_add_f32 v36, v36, v58
    v_add_f32 v38, v38, v74
    v_add_f32 v36, v36, v59
    v_add_f32 v38, v38, v75
    v_add_f32 v36, v36, v60
    v_add_f32 v38, v38, v76
    v_add_f32 v36, v36, v61
    v_add_f32 v38, v38, v77
    v_add_f32 v36, v36, v62
    v_add_f32 v38, v38, v78
    v_add_f32 v36, v36, v63
    v_add_f32 v38, v38, v79
    v_add_f32 v36, v36, v64
    v_add_f32 v38, v38, v80
    v_add_f32 v36, v36, v65
    v_add_f32 v38, v38, v81
    v_add_f32 v36, v36, v66
    v_add_f32 v38, v38, v82
    v_add_f32 v36, v36, v67
    v_add_f32 v38, v38, v83
    v_add_f32 v36, v36, v68
    v_add_f32 v38, v38, v84
    v_add_f32 v36, v36, v69
    v_add_f32 v38, v38, v85
    v_add_f32 v36, v36, v70
    v_add_f32 v38, v38, v86
    v_add_f32 v36, v36, v71
    v_add_f32 v38, v38, v87
L_pt2_e:
    s_nop 2
    s_mul_i32 s79, s78, 96
    s_mul_i32 s80, s83, 48
    s_add_u32 s79, s79, s80
    v_add_lshl_u32 v8, v1, s79, 10
    s_lshl_b32 s79, s77, 7
    s_mov_b32 exec_hi, 65535
    buffer_load_dword v92, v8, s[68:71], s79 offen
    s_mov_b64 exec, -1
    s_barrier
    s_cmp_eq_u32 s86, 0
    s_cbranch_scc1 L_pt3_e
    s_cmp_eq_u32 s86, 2
    s_cbranch_scc1 L_pt3_g
    v_add_u32 v8, 0, v30
    ds_read_b128 v[40:43], v8
    v_add_u32 v9, 0, v31
    ds_read_b128 v[44:47], v9
    v_add_u32 v10, 0, v32
    ds_read_b128 v[48:51], v10
    v_add_u32 v11, 0, v33
    ds_read_b128 v[52:55], v11
    s_branch L_pt3_d
L_pt3_g:
    v_add_u32 v8, 0, v88
    s_waitcnt lgkmcnt(3)
    ds_read_b64_tr_b16 v[40:41], v8 offset:0
    ds_read_b64_tr_b16 v[42:43], v8 offset:256
    s_waitcnt lgkmcnt(4)
    ds_read_b64_tr_b16 v[44:45], v8 offset:3072
    ds_read_b64_tr_b16 v[46:47], v8 offset:3328
    s_waitcnt lgkmcnt(5)
    ds_read_b64_tr_b16 v[48:49], v8 offset:6144
    ds_read_b64_tr_b16 v[50:51], v8 offset:6400
    s_waitcnt lgkmcnt(6)
    ds_read_b64_tr_b16 v[52:53], v8 offset:9216
    ds_read_b64_tr_b16 v[54:55], v8 offset:9472
L_pt3_d:
    s_waitcnt lgkmcnt(0)
    v_lshlrev_b32 v56, 16, v40
    v_and_b32 v72, 0xffff0000, v40
    v_lshlrev_b32 v57, 16, v41
    v_and_b32 v73, 0xffff0000, v41
    v_lshlrev_b32 v58, 16, v42
    v_and_b32 v74, 0xffff0000, v42
    v_lshlrev_b32 v59, 16, v43
    v_and_b32 v75, 0xffff0000, v43
    v_lshlrev_b32 v60, 16, v44
    v_and_b32 v76, 0xffff0000, v44
    v_lshlrev_b32 v61, 16, v45
    v_and_b32 v77, 0xffff0000, v45
    v_lshlrev_b32 v62, 16, v46
    v_and_b32 v78, 0xffff0000, v46
    v_lshlrev_b32 v63, 16, v47
    v_and_b32 v79, 0xffff0000, v47
    v_lshlrev_b32 v64, 16, v48
    v_and_b32 v80, 0xffff0000, v48
    v_lshlrev_b32 v65, 16, v49
    v_and_b32 v81, 0xffff0000, v49
    v_lshlrev_b32 v66, 16, v50
    v_and_b32 v82, 0xffff0000, v50
    v_lshlrev_b32 v67, 16, v51
    v_and_b32 v83, 0xffff0000, v51
    v_lshlrev_b32 v68, 16, v52
    v_and_b32 v84, 0xffff0000, v52
    v_lshlrev_b32 v69, 16, v53
    v_and_b32 v85, 0xffff0000, v53
    v_lshlrev_b32 v70, 16, v54
    v_and_b32 v86, 0xffff0000, v54
    v_lshlrev_b32 v71, 16, v55
    v_and_b32 v87, 0xffff0000, v55
    v_add_f32 v36, v36, v56
    v_add_f32 v38, v38, v72
    v_add_f32 v36, v36, v57
    v_add_f32 v38, v38, v73
    v_add_f32 v36, v36, v58
    v_add_f32 v38, v38, v74
    v_add_f32 v36, v36, v59
    v_add_f32 v38, v38, v75
    v_add_f32 v36, v36, v60
    v_add_f32 v38, v38, v76
    v_add_f32 v36, v36, v61
    v_add_f32 v38, v38, v77
    v_add_f32 v36, v36, v62
    v_add_f32 v38, v38, v78
    v_add_f32 v36, v36, v63
    v_add_f32 v38, v38, v79
    v_add_f32 v36, v36, v64
    v_add_f32 v38, v38, v80
    v_add_f32 v36, v36, v65
    v_add_f32 v38, v38, v81
    v_add_f32 v36, v36, v66
    v_add_f32 v38, v38, v82
    v_add_f32 v36, v36, v67
    v_add_f32 v38, v38, v83
    v_add_f32 v36, v36, v68
    v_add_f32 v38, v38, v84
    v_add_f32 v36, v36, v69
    v_add_f32 v38, v38, v85
    v_add_f32 v36, v36, v70
    v_add_f32 v38, v38, v86
    v_add_f32 v36, v36, v71
    v_add_f32 v38, v38, v87
L_pt3_e:
    s_nop 2
    s_cmp_eq_u32 s83, 1
    s_cbranch_scc0 L_pb1
    v_add_f32 v36, v36, v38
    v_add_f32 v37, v37, v39
    v_mov_b32 v8, v36
    v_mov_b32 v9, v37
    s_nop 0
    v_permlane32_swap_b32 v36, v8
    v_permlane32_swap_b32 v37, v9
    v_add_f32 v36, v36, v8
    v_add_f32 v37, v37, v9
    v_mov_b32 v38, s46
    v_mov_b32 v39, s47
    s_lshl_b32 s79, s75, 4
    s_add_u32 s79, s79, s74
    s_lshl_b32 s79, s79, 9
    s_add_u32 s79, s79, 10616832
    s_mov_b32 exec_hi, 0
    buffer_store_dwordx4 v[36:39], v5, s[64:67], s79 offen sc0 sc1
    s_mov_b64 exec, -1
L_pb1:
    s_barrier
    s_barrier
    s_lshl_b32 s89, s74, 11
    s_lshl_b32 s79, s83, 10
    s_add_u32 s89, s89, s79
    s_add_u32 s89, s89, 10485760
    s_add_u32 s88, s89, 32768
    s_add_u32 s85, s89, 65536
    s_add_u32 s86, s89, 98304
    s_lshl_b32 s90, s75, 13
    s_lshl_b32 s79, s83, 11
    s_add_u32 s90, s90, s79
    s_add_u32 s90, s90, 10616832
    s_add_u32 s84, s90, 4096
    buffer_load_dwordx4 v[56:59], v5, s[64:67], s89 offen sc0 sc1
    buffer_load_dwordx4 v[60:63], v5, s[64:67], s88 offen sc0 sc1
    buffer_load_dwordx4 v[64:67], v5, s[64:67], s85 offen sc0 sc1
    buffer_load_dwordx4 v[68:71], v5, s[64:67], s86 offen sc0 sc1
    buffer_load_dwordx4 v[72:75], v5, s[64:67], s90 offen offset:0 sc0 sc1
    buffer_load_dwordx4 v[80:83], v5, s[64:67], s90 offen offset:1024 sc0 sc1
    buffer_load_dwordx4 v[76:79], v5, s[64:67], s84 offen offset:0 sc0 sc1
    buffer_load_dwordx4 v[84:87], v5, s[64:67], s84 offen offset:1024 sc0 sc1
    s_barrier
    s_waitcnt vmcnt(7)
    v_cmp_ne_u64 vcc, s[46:47], v[58:59]
    s_nop 0
    s_mov_b64 s[4:5], vcc
    s_waitcnt vmcnt(6)
    v_cmp_ne_u64 vcc, s[46:47], v[62:63]
    s_nop 0
    s_or_b64 s[4:5], s[4:5], vcc
    s_waitcnt vmcnt(5)
    v_cmp_ne_u64 vcc, s[46:47], v[66:67]
    s_nop 0
    s_or_b64 s[4:5], s[4:5], vcc
    s_waitcnt vmcnt(4)
    v_cmp_ne_u64 vcc, s[46:47], v[70:71]
    s_nop 0
    s_or_b64 s[4:5], s[4:5], vcc
    s_waitcnt vmcnt(3)
    v_cmp_ne_u64 vcc, s[46:47], v[74:75]
    s_nop 0
    s_or_b64 s[4:5], s[4:5], vcc
    s_waitcnt vmcnt(1)
    v_cmp_ne_u64 vcc, s[46:47], v[78:79]
    s_nop 0
    s_or_b64 s[4:5], s[4:5], vcc
    v_cmp_ne_u64 vcc, s[46:47], v[82:83]
    s_nop 0
    s_or_b64 s[4:5], s[4:5], vcc
    s_waitcnt vmcnt(0)
    v_cmp_ne_u64 vcc, s[46:47], v[86:87]
    s_nop 0
    s_or_b64 s[4:5], s[4:5], vcc
    s_cmp_eq_u64 s[4:5], 0
    s_cbranch_scc1 L_gf_ok
L_gf_retry:
    s_add_u32 s3, s3, 1
    s_cmp_gt_u32 s3, 1048576
    s_cbranch_scc1 L_gf_ok
    s_sleep 1
    buffer_load_dwordx4 v[56:59], v5, s[64:67], s89 offen sc0 sc1
    buffer_load_dwordx4 v[60:63], v5, s[64:67], s88 offen sc0 sc1
    buffer_load_dwordx4 v[64:67], v5, s[64:67], s85 offen sc0 sc1
    buffer_load_dwordx4 v[68:71], v5, s[64:67], s86 offen sc0 sc1
    buffer_load_dwordx4 v[72:75], v5, s[64:67], s90 offen offset:0 sc0 sc1
    buffer_load_dwordx4 v[80:83], v5, s[64:67], s90 offen offset:1024 sc0 sc1
    buffer_load_dwordx4 v[76:79], v5, s[64:67], s84 offen offset:0 sc0 sc1
    buffer_load_dwordx4 v[84:87], v5, s[64:67], s84 offen offset:1024 sc0 sc1
    s_waitcnt vmcnt(0)
    v_cmp_ne_u64 vcc, s[46:47], v[58:59]
    s_nop 1
    s_mov_b64 s[4:5], vcc
    v_cmp_ne_u64 vcc, s[46:47], v[62:63]
    s_nop 1
    s_or_b64 s[4:5], s[4:5], vcc
    v_cmp_ne_u64 vcc, s[46:47], v[66:67]
    s_nop 1
    s_or_b64 s[4:5], s[4:5], vcc
    v_cmp_ne_u64 vcc, s[46:47], v[70:71]
    s_nop 1
    s_or_b64 s[4:5], s[4:5], vcc
    v_cmp_ne_u64 vcc, s[46:47], v[74:75]
    s_nop 1
    s_or_b64 s[4:5], s[4:5], vcc
    v_cmp_ne_u64 vcc, s[46:47], v[78:79]
    s_nop 1
    s_or_b64 s[4:5], s[4:5], vcc
    v_cmp_ne_u64 vcc, s[46:47], v[82:83]
    s_nop 1
    s_or_b64 s[4:5], s[4:5], vcc
    v_cmp_ne_u64 vcc, s[46:47], v[86:87]
    s_nop 1
    s_or_b64 s[4:5], s[4:5], vcc
    s_cmp_eq_u64 s[4:5], 0
    s_cbranch_scc0 L_gf_retry
L_gf_ok:
    s_lshl_b32 s79, s83, 11
    s_add_u32 s79, s79, 149504
    v_add_u32 v11, s79, v5
    v_add_f32 v72, v72, v76
    v_cvt_pk_bf16_f32 v73, v72, v72
    v_and_b32 v73, 0xffff0000, v73
    v_sub_f32 v74, v72, v73
    v_cvt_pk_bf16_f32 v75, v74, v74
    v_and_b32 v75, 0xffff0000, v75
    v_sub_f32 v74, v74, v75
    v_cvt_pk_bf16_f32 v40, v73, v75
    v_cvt_pk_bf16_f32 v41, v74, v4
    v_mov_b32 v42, 0
    v_mov_b32 v43, 0
    ds_write_b128 v11, v[40:43] offset:0
    v_add_f32 v80, v80, v84
    v_cvt_pk_bf16_f32 v81, v80, v80
    v_and_b32 v81, 0xffff0000, v81
    v_sub_f32 v82, v80, v81
    v_cvt_pk_bf16_f32 v83, v82, v82
    v_and_b32 v83, 0xffff0000, v83
    v_sub_f32 v82, v82, v83
    v_cvt_pk_bf16_f32 v44, v81, v83
    v_cvt_pk_bf16_f32 v45, v82, v4
    v_mov_b32 v46, 0
    v_mov_b32 v47, 0
    ds_write_b128 v11, v[44:47] offset:1024
    v_add_f32 v56, v56, v60
    v_add_f32 v64, v64, v68
    v_add_f32 v57, v57, v61
    v_add_f32 v65, v65, v69
    v_add_f32 v56, v56, v64
    v_add_f32 v57, v57, v65
    v_mul_f32 v56, 0.001953125, v56
    v_mul_f32 v57, 0.001953125, v57
    v_fma_f32 v57, -v56, v56, v57
    v_max_f32 v57, 0, v57
    v_cvt_pk_bf16_f32 v58, v56, v56
    v_and_b32 v58, 0xffff0000, v58
    v_cvt_pk_bf16_f32 v57, v57, v57
    v_and_b32 v57, 0xffff0000, v57
    v_add_f32 v57, 0x3727c5ac, v57
    v_cvt_pk_bf16_f32 v57, v57, v57
    v_and_b32 v57, 0xffff0000, v57
    v_sqrt_f32 v57, v57
    s_nop 0
    v_cvt_pk_bf16_f32 v57, v57, v57
    v_and_b32 v57, 0xffff0000, v57
    v_rcp_f32 v59, v57
    v_sub_f32 v9, 0, v58
    v_cvt_pk_bf16_f32 v48, v9, v9
    v_cvt_pk_bf16_f32 v49, v9, v4
    v_mov_b32 v50, 0
    v_mov_b32 v51, 0
    s_lshl_b32 s79, s83, 10
    s_add_u32 s79, s79, 147456
    v_add_u32 v8, s79, v5
    ds_write_b128 v8, v[48:51]
    v_and_b32 v9, 7, v1
    v_bfe_u32 v10, v1, 3, 1
    v_lshl_add_u32 v9, v9, 1, v10
    v_and_b32 v10, 48, v1
    v_add_u32 v9, v9, v10
    s_lshl_b32 s79, s83, 8
    s_add_u32 s79, s79, 153600
    v_lshl_add_u32 v9, v9, 2, s79
    ds_write_b32 v9, v59
    v_mov_b32 v8, 154112
    ds_write_b64 v8, v[50:51]
    ds_write_b64 v8, v[50:51] offset:8
    s_barrier
    s_waitcnt lgkmcnt(0)
    s_barrier
    s_mul_i32 s79, s78, 76
    s_mul_i32 s80, s83, 38
    s_add_u32 s79, s79, 768
    s_add_u32 s79, s79, s80
    v_add_lshl_u32 v8, v1, s79, 10
    s_lshl_b32 s79, s77, 7
    s_mov_b32 exec_hi, 63
    buffer_load_dword v92, v8, s[68:71], s79 offen
    s_mov_b64 exec, -1
    s_cmp_eq_u32 s83, 0
    s_cselect_b32 s12, s26, s28
    s_cselect_b32 s13, s27, s29
    s_lshl_b32 s79, s77, 16
    s_lshl_b32 s80, s78, 13
    s_add_u32 s79, s79, s80
    v_lshl_add_u32 v8, v1, 7, s79
    global_load_dword v93, v8, s[12:13]
    s_waitcnt vmcnt(0)
L_p2:
    s_lshr_b32 s83, s73, 1
    s_and_b32 s84, s73, 1
    s_mov_b32 s85, 1069066811
    v_bfe_u32 v16, v1, 4, 1
    v_bfe_u32 v17, v1, 2, 2
    v_and_b32 v18, 3, v1
    v_and_b32 v8, 31, v1
    s_lshl_b32 s79, s77, 6
    v_add_u32 v8, s79, v8
    s_lshl_b32 s79, s84, 5
    v_add_u32 v8, s79, v8
    s_lshl_b32 s79, s76, 6
    v_lshl_add_u32 v9, v2, 2, s79
    s_lshl_b32 s79, s83, 5
    v_add_u32 v9, s79, v9
    v_lshlrev_b32 v55, 10, v9
    v_lshl_add_u32 v55, v8, 1, v55
    v_lshlrev_b32 v53, 1, v55
    s_mov_b32 s8, 0
    s_mov_b32 s9, 4096
    s_mov_b32 s10, 16384
    s_mov_b32 s11, 20480
    s_mov_b32 s12, 32768
    s_mov_b32 s13, 36864
    s_mov_b32 s14, 49152
    s_mov_b32 s15, 53248
    v_lshlrev_b32 v57, 1, v8
    s_lshl_b32 s79, s76, 6
    s_lshl_b32 s80, s83, 5
    s_add_u32 s79, s79, s80
    v_and_b32 v10, 31, v1
    v_add_lshl_u32 v56, v10, s79, 4
    v_lshrrev_b32 v10, 2, v1
    v_add_lshl_u32 v55, v10, s79, 10
    v_lshl_add_u32 v55, v18, 4, v55
    s_lshl_b32 s79, s77, 7
    s_lshl_b32 s80, s84, 6
    s_add_u32 s79, s79, s80
    v_add_u32 v55, s79, v55
    v_lshrrev_b32 v8, 1, v18
    v_lshl_add_u32 v8, v16, 1, v8
    v_lshl_add_u32 v9, v2, 3, v17
    v_lshlrev_b32 v10, 2, v8
    v_xor_b32 v10, v10, v9
    v_lshl_add_u32 v10, v8, 4, v10
    v_lshlrev_b32 v10, 4, v10
    v_and_b32 v11, 1, v18
    v_lshl_add_u32 v10, v11, 3, v10
    s_lshl_b32 s79, s83, 12
    v_add_u32 v28, s79, v10
    v_xor_b32 v29, 64, v28
    v_lshlrev_b32 v10, 7, v9
    v_lshrrev_b32 v11, 1, v17
    v_xor_b32 v11, s84, v11
    v_lshl_add_u32 v10, v11, 6, v10
    v_lshl_add_u32 v10, v16, 5, v10
    v_lshl_add_u32 v30, v18, 3, v10
    v_and_b32 v8, 31, v1
    s_lshl_b32 s79, s84, 5
    v_add_u32 v8, s79, v8
    v_bfe_u32 v9, v8, 1, 3
    v_xor_b32 v9, v9, v2
    v_lshlrev_b32 v8, 7, v8
    v_xor_b32 v10, 0, v9
    v_lshl_add_u32 v31, v10, 4, v8
    v_xor_b32 v10, 2, v9
    v_lshl_add_u32 v32, v10, 4, v8
    v_xor_b32 v10, 4, v9
    v_lshl_add_u32 v33, v10, 4, v8
    v_xor_b32 v10, 6, v9
    v_lshl_add_u32 v34, v10, 4, v8
    v_add_u32 v35, 0, v28
    v_add_u32 v36, 0, v29
    v_add_u32 v41, 0, v30
    v_add_u32 v37, 57344, v28
    v_add_u32 v38, 57344, v29
    v_add_u32 v45, 57344, v30
    v_add_u32 v39, 114688, v28
    v_add_u32 v40, 114688, v29
    v_add_u32 v49, 114688, v30
    v_lshrrev_b32 v8, 3, v1
    v_and_b32 v9, 7, v1
    v_bfe_u32 v10, v1, 4, 1
    v_lshlrev_b32 v10, 2, v10
    v_xor_b32 v10, v10, v9
    s_lshl_b32 s79, s73, 4
    v_add_u32 v11, s79, v8
    v_lshlrev_b32 v11, 10, v11
    v_lshl_add_u32 v11, v10, 4, v11
    s_lshl_b32 s79, s77, 7
    v_add_u32 v24, s79, v11
    v_add_u32 v25, 7168, v24
    v_lshrrev_b32 v8, 3, v1
    v_and_b32 v9, 7, v1
    v_lshrrev_b32 v10, 1, v8
    v_xor_b32 v10, v10, v9
    s_lshl_b32 s79, s77, 6
    s_lshl_b32 s80, s73, 4
    s_add_u32 s79, s79, s80
    v_add_u32 v11, s79, v8
    v_lshlrev_b32 v11, 10, v11
    v_lshl_add_u32 v26, v10, 4, v11
    v_xor_b32 v10, 4, v10
    v_lshl_add_u32 v27, v10, 4, v11
    v_add_u32 v27, 7168, v27
    s_lshl_b32 s79, s76, 1
    s_add_u32 s79, s79, s83
    s_mul_i32 s79, s79, 150
    s_lshl_b32 s80, s84, 1
    s_add_u32 s87, s79, s80
    s_add_u32 s88, s87, s80
    s_add_u32 s88, s88, 86
    s_lshl_b32 s87, s87, 10
    s_lshl_b32 s88, s88, 10
    s_lshl_b32 s89, s73, 11
    v_lshlrev_b32 v19, 3, v1
    v_and_b32 v20, 0x7f, v19
    v_and_b32 v19, 0xff, v19
    s_lshl_b32 s90, s76, 8
    s_add_u32 s90, s90, 11337728
    s_lshl_b32 s91, s76, 7
    s_add_u32 s91, s91, 11354112
    s_mov_b32 s52, s26
    s_mov_b32 s53, s27
    s_mov_b32 s54, 524288
    s_mov_b32 s55, 0x20000
    s_mov_b32 s56, s28
    s_mov_b32 s57, s29
    s_mov_b32 s58, 524288
    s_mov_b32 s59, 0x20000
    s_mov_b32 s60, s38
    s_mov_b32 s61, s39
    s_mov_b32 s62, 4194304
    s_mov_b32 s63, 0x20000
    s_mov_b32 s86, 10485760
    s_mov_b32 s92, 10551296
    v_lshl_add_u32 v56, v2, 15, v56
    buffer_load_dwordx4 v[172:175], v56, s[64:67], s86 offen sc0 sc1
    buffer_load_dwordx4 v[176:179], v56, s[64:67], s92 offen sc0 sc1
    global_load_ushort v54, v57, s[44:45]
    s_add_u32 m0, s89, 155648
    s_movk_i32 s79, 15360
    buffer_load_dwordx4 v55, s[48:51], 0 offen lds
    buffer_load_dwordx4 v55, s[48:51], s79 offen offset:1024 lds
    s_waitcnt vmcnt(4)
    v_cmp_ne_u64 vcc, s[46:47], v[174:175]
    s_nop 0
    s_mov_b64 s[4:5], vcc
    s_waitcnt vmcnt(3)
    v_cmp_ne_u64 vcc, s[46:47], v[178:179]
    s_nop 0
    s_or_b64 s[4:5], s[4:5], vcc
    s_cmp_eq_u64 s[4:5], 0
    s_cbranch_scc1 L_mr_ok
L_mr_retry:
    s_add_u32 s3, s3, 1
    s_cmp_gt_u32 s3, 1048576
    s_cbranch_scc1 L_mr_ok
    s_sleep 1
    buffer_load_dwordx4 v[172:175], v56, s[64:67], s86 offen sc0 sc1
    buffer_load_dwordx4 v[176:179], v56, s[64:67], s92 offen sc0 sc1
    s_waitcnt vmcnt(0)
    v_cmp_ne_u64 vcc, s[46:47], v[174:175]
    s_nop 1
    s_mov_b64 s[4:5], vcc
    v_cmp_ne_u64 vcc, s[46:47], v[178:179]
    s_nop 1
    s_or_b64 s[4:5], s[4:5], vcc
    s_cmp_eq_u64 s[4:5], 0
    s_cbranch_scc0 L_mr_retry
L_mr_ok:
    v_mov_b32 v8, v172
    s_nop 1
    v_permlane32_swap_b32 v172, v8
    v_add_f32 v172, v172, v8
    v_mov_b32 v8, v176
    s_nop 1
    v_permlane32_swap_b32 v176, v8
    v_add_f32 v176, v176, v8
    v_add_f32 v180, v172, v176
    v_mov_b32 v8, v173
    s_nop 1
    v_permlane32_swap_b32 v173, v8
    v_add_f32 v173, v173, v8
    v_mov_b32 v8, v177
    s_nop 1
    v_permlane32_swap_b32 v177, v8
    v_add_f32 v177, v177, v8
    v_add_f32 v181, v173, v177
    v_mul_f32 v180, 0.001953125, v180
    v_mul_f32 v181, 0.001953125, v181
    v_fma_f32 v181, -v180, v180, v181
    v_max_f32 v181, 0, v181
    v_cvt_pk_bf16_f32 v172, v180, v180
    v_and_b32 v172, 0xffff0000, v172
    v_cvt_pk_bf16_f32 v181, v181, v181
    v_and_b32 v181, 0xffff0000, v181
    v_add_f32 v181, 0x3727c5ac, v181
    v_cvt_pk_bf16_f32 v181, v181, v181
    v_and_b32 v181, 0xffff0000, v181
    v_sqrt_f32 v181, v181
    s_nop 0
    v_cvt_pk_bf16_f32 v181, v181, v181
    v_and_b32 v181, 0xffff0000, v181
    v_rcp_f32 v173, v181
    s_lshl_b32 s79, s73, 8
    s_add_u32 s79, s79, 154368
    v_and_b32 v8, 31, v1
    v_lshl_add_u32 v9, v8, 3, s79
    ds_write_b64 v9, v[172:173]
    v_lshl_add_u32 v9, v2, 5, s79
    s_add_u32 s79, s89, 155648
    v_lshl_add_u32 v8, v8, 1, s79
    v_lshl_add_u32 v8, v2, 8, v8
    v_mov_b32 v55, v8
    v_mov_b32 v56, v9
    s_waitcnt lgkmcnt(0)
    s_waitcnt vmcnt(0)
    ds_read_b128 v[124:127], v56 offset:0
    ds_read_b128 v[128:131], v56 offset:16
    ds_read_b128 v[132:135], v56 offset:64
    ds_read_b128 v[136:139], v56 offset:80
    ds_read_b128 v[140:143], v56 offset:128
    ds_read_b128 v[144:147], v56 offset:144
    ds_read_b128 v[148:151], v56 offset:192
    ds_read_b128 v[152:155], v56 offset:208
    ds_read_u16 v92, v55 offset:0
    ds_read_u16 v93, v55 offset:64
    ds_read_u16 v94, v55 offset:128
    ds_read_u16 v95, v55 offset:192
    ds_read_u16 v96, v55 offset:512
    ds_read_u16 v97, v55 offset:576
    ds_read_u16 v98, v55 offset:640
    ds_read_u16 v99, v55 offset:704
    ds_read_u16 v100, v55 offset:1024
    ds_read_u16 v101, v55 offset:1088
    ds_read_u16 v102, v55 offset:1152
    ds_read_u16 v103, v55 offset:1216
    ds_read_u16 v104, v55 offset:1536
    ds_read_u16 v105, v55 offset:1600
    ds_read_u16 v106, v55 offset:1664
    ds_read_u16 v107, v55 offset:1728
    s_waitcnt lgkmcnt(0)
    s_cmp_eq_u32 s73, 0
    s_cbranch_scc0 L_nf1
    buffer_load_dwordx2 v[22:23], v19, s[64:67], s90 offen sc0 sc1
    s_waitcnt vmcnt(0)
    v_cmp_ne_u64 vcc, s[46:47], v[22:23]
    s_nop 0
    s_mov_b64 s[4:5], vcc
    s_cmp_eq_u64 s[4:5], 0
    s_cbranch_scc1 L_f1_ok
L_f1_retry:
    s_add_u32 s3, s3, 1
    s_cmp_gt_u32 s3, 1048576
    s_cbranch_scc1 L_f1_ok
    s_sleep 1
    buffer_load_dwordx2 v[22:23], v19, s[64:67], s90 offen sc0 sc1
    s_waitcnt vmcnt(0)
    v_cmp_ne_u64 vcc, s[46:47], v[22:23]
    s_nop 1
    s_mov_b64 s[4:5], vcc
    s_cmp_eq_u64 s[4:5], 0
    s_cbranch_scc0 L_f1_retry
L_f1_ok:
    s_mov_b32 m0, 49152
    s_add_u32 s82, s87, 0
    buffer_load_dwordx4 v5, s[64:67], s82 offen offset:0 sc1 lds
    buffer_load_dwordx4 v5, s[64:67], s82 offen offset:1024 sc1 lds
    buffer_load_dwordx4 v5, s[64:67], s82 offen offset:2048 sc1 lds
    buffer_load_dwordx4 v5, s[64:67], s82 offen offset:3072 sc1 lds
    s_mov_b32 m0, 53248
    s_add_u32 s82, s87, 153600
    buffer_load_dwordx4 v5, s[64:67], s82 offen offset:0 sc1 lds
    buffer_load_dwordx4 v5, s[64:67], s82 offen offset:1024 sc1 lds
    buffer_load_dwordx4 v5, s[64:67], s82 offen offset:2048 sc1 lds
    buffer_load_dwordx4 v5, s[64:67], s82 offen offset:3072 sc1 lds
    s_mov_b32 m0, 57344
    s_add_u32 s82, s87, 4096
    buffer_load_dwordx4 v5, s[64:67], s82 offen offset:0 sc1 lds
    buffer_load_dwordx4 v5, s[64:67], s82 offen offset:1024 sc1 lds
    buffer_load_dwordx4 v5, s[64:67], s82 offen offset:2048 sc1 lds
    buffer_load_dwordx4 v5, s[64:67], s82 offen offset:3072 sc1 lds
    s_mov_b32 m0, 61440
    s_add_u32 s82, s87, 157696
    buffer_load_dwordx4 v5, s[64:67], s82 offen offset:0 sc1 lds
    buffer_load_dwordx4 v5, s[64:67], s82 offen offset:1024 sc1 lds
    buffer_load_dwordx4 v5, s[64:67], s82 offen offset:2048 sc1 lds
    buffer_load_dwordx4 v5, s[64:67], s82 offen offset:3072 sc1 lds
    s_mov_b32 m0, 65536
    s_add_u32 s82, s87, 8192
    buffer_load_dwordx4 v5, s[64:67], s82 offen offset:0 sc1 lds
    buffer_load_dwordx4 v5, s[64:67], s82 offen offset:1024 sc1 lds
    buffer_load_dwordx4 v5, s[64:67], s82 offen offset:2048 sc1 lds
    buffer_load_dwordx4 v5, s[64:67], s82 offen offset:3072 sc1 lds
    s_mov_b32 m0, 69632
    s_add_u32 s82, s87, 161792
    buffer_load_dwordx4 v5, s[64:67], s82 offen offset:0 sc1 lds
    buffer_load_dwordx4 v5, s[64:67], s82 offen offset:1024 sc1 lds
    buffer_load_dwordx4 v5, s[64:67], s82 offen offset:2048 sc1 lds
    buffer_load_dwordx4 v5, s[64:67], s82 offen offset:3072 sc1 lds
    s_mov_b32 m0, 73728
    s_add_u32 s82, s87, 12288
    buffer_load_dwordx4 v5, s[64:67], s82 offen offset:0 sc1 lds
    buffer_load_dwordx4 v5, s[64:67], s82 offen offset:1024 sc1 lds
    buffer_load_dwordx4 v5, s[64:67], s82 offen offset:2048 sc1 lds
    buffer_load_dwordx4 v5, s[64:67], s82 offen offset:3072 sc1 lds
    s_mov_b32 m0, 77824
    s_add_u32 s82, s87, 165888
    buffer_load_dwordx4 v5, s[64:67], s82 offen offset:0 sc1 lds
    buffer_load_dwordx4 v5, s[64:67], s82 offen offset:1024 sc1 lds
    buffer_load_dwordx4 v5, s[64:67], s82 offen offset:2048 sc1 lds
    buffer_load_dwordx4 v5, s[64:67], s82 offen offset:3072 sc1 lds
    s_mov_b32 m0, 81920
    s_add_u32 s82, s87, 16384
    buffer_load_dwordx4 v5, s[64:67], s82 offen offset:0 sc1 lds
    buffer_load_dwordx4 v5, s[64:67], s82 offen offset:1024 sc1 lds
    buffer_load_dwordx4 v5, s[64:67], s82 offen offset:2048 sc1 lds
    buffer_load_dwordx4 v5, s[64:67], s82 offen offset:3072 sc1 lds
    s_mov_b32 m0, 86016
    s_add_u32 s82, s87, 169984
    buffer_load_dwordx4 v5, s[64:67], s82 offen offset:0 sc1 lds
    buffer_load_dwordx4 v5, s[64:67], s82 offen offset:1024 sc1 lds
    buffer_load_dwordx4 v5, s[64:67], s82 offen offset:2048 sc1 lds
    buffer_load_dwordx4 v5, s[64:67], s82 offen offset:3072 sc1 lds
    s_mov_b32 m0, 90112
    s_add_u32 s82, s87, 20480
    buffer_load_dwordx4 v5, s[64:67], s82 offen offset:0 sc1 lds
    buffer_load_dwordx4 v5, s[64:67], s82 offen offset:1024 sc1 lds
    buffer_load_dwordx4 v5, s[64:67], s82 offen offset:2048 sc1 lds
    buffer_load_dwordx4 v5, s[64:67], s82 offen offset:3072 sc1 lds
    s_mov_b32 m0, 94208
    s_add_u32 s82, s87, 174080
    buffer_load_dwordx4 v5, s[64:67], s82 offen offset:0 sc1 lds
    buffer_load_dwordx4 v5, s[64:67], s82 offen offset:1024 sc1 lds
    buffer_load_dwordx4 v5, s[64:67], s82 offen offset:2048 sc1 lds
    buffer_load_dwordx4 v5, s[64:67], s82 offen offset:3072 sc1 lds
    s_branch L_nf1e
L_nf1:
    s_waitcnt vmcnt(0)
L_nf1e:
    v_lshlrev_b32 v54, 16, v54
    v_lshlrev_b32 v92, 16, v92
    v_lshlrev_b32 v93, 16, v93
    v_lshlrev_b32 v94, 16, v94
    v_lshlrev_b32 v95, 16, v95
    v_sub_f32 v108, v92, v124
    v_sub_f32 v109, v93, v126
    v_sub_f32 v110, v94, v128
    v_sub_f32 v111, v95, v130
    v_mul_f32 v156, v125, v125
    v_mul_f32 v157, v127, v127
    v_mul_f32 v158, v129, v129
    v_mul_f32 v159, v131, v131
    v_cvt_pk_bf16_f32 v108, v108, v108
    v_cvt_pk_bf16_f32 v109, v109, v109
    v_cvt_pk_bf16_f32 v110, v110, v110
    v_cvt_pk_bf16_f32 v111, v111, v111
    v_and_b32 v108, 0xffff0000, v108
    v_and_b32 v109, 0xffff0000, v109
    v_and_b32 v110, 0xffff0000, v110
    v_and_b32 v111, 0xffff0000, v111
    v_mul_f32 v108, v108, v125
    v_mul_f32 v109, v109, v127
    v_mul_f32 v110, v110, v129
    v_mul_f32 v111, v111, v131
    v_cvt_pk_bf16_f32 v108, v108, v108
    v_cvt_pk_bf16_f32 v109, v109, v109
    v_cvt_pk_bf16_f32 v110, v110, v110
    v_cvt_pk_bf16_f32 v111, v111, v111
    v_and_b32 v108, 0xffff0000, v108
    v_and_b32 v109, 0xffff0000, v109
    v_and_b32 v110, 0xffff0000, v110
    v_and_b32 v111, 0xffff0000, v111
    v_mul_f32 v108, v108, v54
    v_mul_f32 v109, v109, v54
    v_mul_f32 v110, v110, v54
    v_mul_f32 v111, v111, v54
    v_cvt_pk_bf16_f32 v108, v108, v108
    v_cvt_pk_bf16_f32 v109, v109, v109
    v_cvt_pk_bf16_f32 v110, v110, v110
    v_cvt_pk_bf16_f32 v111, v111, v111
    v_and_b32 v108, 0xffff0000, v108
    v_and_b32 v109, 0xffff0000, v109
    v_and_b32 v110, 0xffff0000, v110
    v_and_b32 v111, 0xffff0000, v111
    v_lshlrev_b32 v96, 16, v96
    v_lshlrev_b32 v97, 16, v97
    v_lshlrev_b32 v98, 16, v98
    v_lshlrev_b32 v99, 16, v99
    v_sub_f32 v112, v96, v132
    v_sub_f32 v113, v97, v134
    v_sub_f32 v114, v98, v136
    v_sub_f32 v115, v99, v138
    v_mul_f32 v160, v133, v133
    v_mul_f32 v161, v135, v135
    v_mul_f32 v162, v137, v137
    v_mul_f32 v163, v139, v139
    v_cvt_pk_bf16_f32 v112, v112, v112
    v_cvt_pk_bf16_f32 v113, v113, v113
    v_cvt_pk_bf16_f32 v114, v114, v114
    v_cvt_pk_bf16_f32 v115, v115, v115
    v_and_b32 v112, 0xffff0000, v112
    v_and_b32 v113, 0xffff0000, v113
    v_and_b32 v114, 0xffff0000, v114
    v_and_b32 v115, 0xffff0000, v115
    v_mul_f32 v112, v112, v133
    v_mul_f32 v113, v113, v135
    v_mul_f32 v114, v114, v137
    v_mul_f32 v115, v115, v139
    v_cvt_pk_bf16_f32 v112, v112, v112
    v_cvt_pk_bf16_f32 v113, v113, v113
    v_cvt_pk_bf16_f32 v114, v114, v114
    v_cvt_pk_bf16_f32 v115, v115, v115
    v_and_b32 v112, 0xffff0000, v112
    v_and_b32 v113, 0xffff0000, v113
    v_and_b32 v114, 0xffff0000, v114
    v_and_b32 v115, 0xffff0000, v115
    v_mul_f32 v112, v112, v54
    v_mul_f32 v113, v113, v54
    v_mul_f32 v114, v114, v54
    v_mul_f32 v115, v115, v54
    v_cvt_pk_bf16_f32 v112, v112, v112
    v_cvt_pk_bf16_f32 v113, v113, v113
    v_cvt_pk_bf16_f32 v114, v114, v114
    v_cvt_pk_bf16_f32 v115, v115, v115
    v_and_b32 v112, 0xffff0000, v112
    v_and_b32 v113, 0xffff0000, v113
    v_and_b32 v114, 0xffff0000, v114
    v_and_b32 v115, 0xffff0000, v115
    v_lshlrev_b32 v100, 16, v100
    v_lshlrev_b32 v101, 16, v101
    v_lshlrev_b32 v102, 16, v102
    v_lshlrev_b32 v103, 16, v103
    v_sub_f32 v116, v100, v140
    v_sub_f32 v117, v101, v142
    v_sub_f32 v118, v102, v144
    v_sub_f32 v119, v103, v146
    v_mul_f32 v164, v141, v141
    v_mul_f32 v165, v143, v143
    v_mul_f32 v166, v145, v145
    v_mul_f32 v167, v147, v147
    v_cvt_pk_bf16_f32 v116, v116, v116
    v_cvt_pk_bf16_f32 v117, v117, v117
    v_cvt_pk_bf16_f32 v118, v118, v118
    v_cvt_pk_bf16_f32 v119, v119, v119
    v_and_b32 v116, 0xffff0000, v116
    v_and_b32 v117, 0xffff0000, v117
    v_and_b32 v118, 0xffff0000, v118
    v_and_b32 v119, 0xffff0000, v119
    v_mul_f32 v116, v116, v141
    v_mul_f32 v117, v117, v143
    v_mul_f32 v118, v118, v145
    v_mul_f32 v119, v119, v147
    v_cvt_pk_bf16_f32 v116, v116, v116
    v_cvt_pk_bf16_f32 v117, v117, v117
    v_cvt_pk_bf16_f32 v118, v118, v118
    v_cvt_pk_bf16_f32 v119, v119, v119
    v_and_b32 v116, 0xffff0000, v116
    v_and_b32 v117, 0xffff0000, v117
    v_and_b32 v118, 0xffff0000, v118
    v_and_b32 v119, 0xffff0000, v119
    v_mul_f32 v116, v116, v54
    v_mul_f32 v117, v117, v54
    v_mul_f32 v118, v118, v54
    v_mul_f32 v119, v119, v54
    v_cvt_pk_bf16_f32 v116, v116, v116
    v_cvt_pk_bf16_f32 v117, v117, v117
    v_cvt_pk_bf16_f32 v118, v118, v118
    v_cvt_pk_bf16_f32 v119, v119, v119
    v_and_b32 v116, 0xffff0000, v116
    v_and_b32 v117, 0xffff0000, v117
    v_and_b32 v118, 0xffff0000, v118
    v_and_b32 v119, 0xffff0000, v119
    v_lshlrev_b32 v104, 16, v104
    v_lshlrev_b32 v105, 16, v105
    v_lshlrev_b32 v106, 16, v106
    v_lshlrev_b32 v107, 16, v107
    v_sub_f32 v120, v104, v148
    v_sub_f32 v121, v105, v150
    v_sub_f32 v122, v106, v152
    v_sub_f32 v123, v107, v154
    v_mul_f32 v168, v149, v149
    v_mul_f32 v169, v151, v151
    v_mul_f32 v170, v153, v153
    v_mul_f32 v171, v155, v155
    v_cvt_pk_bf16_f32 v120, v120, v120
    v_cvt_pk_bf16_f32 v121, v121, v121
    v_cvt_pk_bf16_f32 v122, v122, v122
    v_cvt_pk_bf16_f32 v123, v123, v123
    v_and_b32 v120, 0xffff0000, v120
    v_and_b32 v121, 0xffff0000, v121
    v_and_b32 v122, 0xffff0000, v122
    v_and_b32 v123, 0xffff0000, v123
    v_mul_f32 v120, v120, v149
    v_mul_f32 v121, v121, v151
    v_mul_f32 v122, v122, v153
    v_mul_f32 v123, v123, v155
    v_cvt_pk_bf16_f32 v120, v120, v120
    v_cvt_pk_bf16_f32 v121, v121, v121
    v_cvt_pk_bf16_f32 v122, v122, v122
    v_cvt_pk_bf16_f32 v123, v123, v123
    v_and_b32 v120, 0xffff0000, v120
    v_and_b32 v121, 0xffff0000, v121
    v_and_b32 v122, 0xffff0000, v122
    v_and_b32 v123, 0xffff0000, v123
    v_mul_f32 v120, v120, v54
    v_mul_f32 v121, v121, v54
    v_mul_f32 v122, v122, v54
    v_mul_f32 v123, v123, v54
    v_cvt_pk_bf16_f32 v120, v120, v120
    v_cvt_pk_bf16_f32 v121, v121, v121
    v_cvt_pk_bf16_f32 v122, v122, v122
    v_cvt_pk_bf16_f32 v123, v123, v123
    v_and_b32 v120, 0xffff0000, v120
    v_and_b32 v121, 0xffff0000, v121
    v_and_b32 v122, 0xffff0000, v122
    v_and_b32 v123, 0xffff0000, v123
    s_waitcnt vmcnt(32)
    s_barrier
    ds_read_b64_tr_b16 v[172:173], v35 offset:49152
    ds_read_b64_tr_b16 v[174:175], v36 offset:49152
    ds_read_b64_tr_b16 v[204:205], v45 offset:40960
    ds_read_b64_tr_b16 v[206:207], v45 offset:41472
    ds_read_b64_tr_b16 v[176:177], v35 offset:50176
    ds_read_b64_tr_b16 v[178:179], v36 offset:50176
    ds_read_b64_tr_b16 v[208:209], v45 offset:43008
    ds_read_b64_tr_b16 v[210:211], v45 offset:43520
    ds_read_b64_tr_b16 v[180:181], v35 offset:51200
    ds_read_b64_tr_b16 v[182:183], v36 offset:51200
    ds_read_b64_tr_b16 v[212:213], v45 offset:45056
    ds_read_b64_tr_b16 v[214:215], v45 offset:45568
    ds_read_b64_tr_b16 v[184:185], v35 offset:52224
    ds_read_b64_tr_b16 v[186:187], v36 offset:52224
    ds_read_b64_tr_b16 v[216:217], v45 offset:47104
    ds_read_b64_tr_b16 v[218:219], v45 offset:47616
    s_waitcnt lgkmcnt(12)
    v_mfma_f32_32x32x16_bf16 v[60:75], v[172:175], v[204:207], 0
    ds_read_b64_tr_b16 v[188:189], v37 offset:0
    ds_read_b64_tr_b16 v[190:191], v38 offset:0
    ds_read_b64_tr_b16 v[220:221], v45 offset:49152
    ds_read_b64_tr_b16 v[222:223], v45 offset:49664
    s_waitcnt lgkmcnt(12)
    v_mfma_f32_32x32x16_bf16 v[60:75], v[176:179], v[208:211], v[60:75]
    ds_read_b64_tr_b16 v[192:193], v37 offset:1024
    ds_read_b64_tr_b16 v[194:195], v38 offset:1024
    ds_read_b64_tr_b16 v[224:225], v45 offset:51200
    ds_read_b64_tr_b16 v[226:227], v45 offset:51712
    s_add_u32 m0, s89, 147456
    s_add_u32 s82, s87, 24576
    buffer_load_dwordx4 v5, s[64:67], s82 offen offset:0 sc1 lds
    buffer_load_dwordx4 v5, s[64:67], s82 offen offset:1024 sc1 lds
    s_waitcnt lgkmcnt(12)
    v_mfma_f32_32x32x16_bf16 v[60:75], v[180:183], v[212:215], v[60:75]
    ds_read_b64_tr_b16 v[196:197], v37 offset:2048
    ds_read_b64_tr_b16 v[198:199], v38 offset:2048
    ds_read_b64_tr_b16 v[228:229], v45 offset:53248
    ds_read_b64_tr_b16 v[230:231], v45 offset:53760
    s_waitcnt lgkmcnt(12)
    v_mfma_f32_32x32x16_bf16 v[60:75], v[184:187], v[216:219], v[60:75]
    ds_read_b64_tr_b16 v[200:201], v37 offset:3072
    ds_read_b64_tr_b16 v[202:203], v38 offset:3072
    ds_read_b64_tr_b16 v[232:233], v45 offset:55296
    ds_read_b64_tr_b16 v[234:235], v45 offset:55808
    s_add_u32 m0, s89, 155648
    s_add_u32 s82, s87, 28672
    buffer_load_dwordx4 v5, s[64:67], s82 offen offset:0 sc1 lds
    buffer_load_dwordx4 v5, s[64:67], s82 offen offset:1024 sc1 lds
    s_waitcnt vmcnt(20)
    s_barrier
    s_waitcnt lgkmcnt(12)
    v_mfma_f32_32x32x16_bf16 v[60:75], v[188:191], v[220:223], v[60:75]
    ds_read_b64_tr_b16 v[172:173], v37 offset:8192
    ds_read_b64_tr_b16 v[174:175], v38 offset:8192
    ds_read_b64_tr_b16 v[204:205], v49 offset:0
    ds_read_b64_tr_b16 v[206:207], v49 offset:512
    s_waitcnt lgkmcnt(12)
    v_mfma_f32_32x32x16_bf16 v[60:75], v[192:195], v[224:227], v[60:75]
    ds_read_b64_tr_b16 v[176:177], v37 offset:9216
    ds_read_b64_tr_b16 v[178:179], v38 offset:9216
    ds_read_b64_tr_b16 v[208:209], v49 offset:2048
    ds_read_b64_tr_b16 v[210:211], v49 offset:2560
    s_waitcnt lgkmcnt(12)
    v_mfma_f32_32x32x16_bf16 v[60:75], v[196:199], v[228:231], v[60:75]
    ds_read_b64_tr_b16 v[180:181], v37 offset:10240
    ds_read_b64_tr_b16 v[182:183], v38 offset:10240
    ds_read_b64_tr_b16 v[212:213], v49 offset:4096
    ds_read_b64_tr_b16 v[214:215], v49 offset:4608
    s_waitcnt lgkmcnt(12)
    v_mfma_f32_32x32x16_bf16 v[60:75], v[200:203], v[232:235], v[60:75]
    ds_read_b64_tr_b16 v[184:185], v37 offset:11264
    ds_read_b64_tr_b16 v[186:187], v38 offset:11264
    ds_read_b64_tr_b16 v[216:217], v49 offset:6144
    ds_read_b64_tr_b16 v[218:219], v49 offset:6656
    s_add_u32 m0, s89, 49152
    s_add_u32 s82, s87, 32768
    buffer_load_dwordx4 v5, s[64:67], s82 offen offset:0 sc1 lds
    buffer_load_dwordx4 v5, s[64:67], s82 offen offset:1024 sc1 lds
    s_waitcnt lgkmcnt(12)
    v_mfma_f32_32x32x16_bf16 v[60:75], v[172:175], v[204:207], v[60:75]
    ds_read_b64_tr_b16 v[188:189], v37 offset:16384
    ds_read_b64_tr_b16 v[190:191], v38 offset:16384
    ds_read_b64_tr_b16 v[220:221], v49 offset:8192
    ds_read_b64_tr_b16 v[222:223], v49 offset:8704
    s_waitcnt lgkmcnt(12)
    v_mfma_f32_32x32x16_bf16 v[60:75], v[176:179], v[208:211], v[60:75]
    ds_read_b64_tr_b16 v[192:193], v37 offset:17408
    ds_read_b64_tr_b16 v[194:195], v38 offset:17408
    ds_read_b64_tr_b16 v[224:225], v49 offset:10240
    ds_read_b64_tr_b16 v[226:227], v49 offset:10752
    s_waitcnt lgkmcnt(12)
    v_mfma_f32_32x32x16_bf16 v[60:75], v[180:183], v[212:215], v[60:75]
    ds_read_b64_tr_b16 v[196:197], v37 offset:18432
    ds_read_b64_tr_b16 v[198:199], v38 offset:18432
    ds_read_b64_tr_b16 v[228:229], v49 offset:12288
    ds_read_b64_tr_b16 v[230:231], v49 offset:12800
    s_waitcnt lgkmcnt(12)
    v_mfma_f32_32x32x16_bf16 v[60:75], v[184:187], v[216:219], v[60:75]
    ds_read_b64_tr_b16 v[200:201], v37 offset:19456
    ds_read_b64_tr_b16 v[202:203], v38 offset:19456
    ds_read_b64_tr_b16 v[232:233], v49 offset:14336
    ds_read_b64_tr_b16 v[234:235], v49 offset:14848
    s_add_u32 m0, s89, 98304
    s_add_u32 s82, s87, 36864
    buffer_load_dwordx4 v5, s[64:67], s82 offen offset:0 sc1 lds
    buffer_load_dwordx4 v5, s[64:67], s82 offen offset:1024 sc1 lds
    s_waitcnt vmcnt(8)
    s_barrier
    s_waitcnt lgkmcnt(12)
    v_mfma_f32_32x32x16_bf16 v[60:75], v[188:191], v[220:223], v[60:75]
    ds_read_b64_tr_b16 v[172:173], v37 offset:24576
    ds_read_b64_tr_b16 v[174:175], v38 offset:24576
    ds_read_b64_tr_b16 v[204:205], v49 offset:16384
    ds_read_b64_tr_b16 v[206:207], v49 offset:16896
    s_waitcnt lgkmcnt(12)
    v_mfma_f32_32x32x16_bf16 v[60:75], v[192:195], v[224:227], v[60:75]
    ds_read_b64_tr_b16 v[176:177], v37 offset:25600
    ds_read_b64_tr_b16 v[178:179], v38 offset:25600
    ds_read_b64_tr_b16 v[208:209], v49 offset:18432
    ds_read_b64_tr_b16 v[210:211], v49 offset:18944
    s_add_u32 m0, s89, 57344
    s_add_u32 s82, s87, 40960
    buffer_load_dwordx4 v5, s[64:67], s82 offen offset:0 sc1 lds
    buffer_load_dwordx4 v5, s[64:67], s82 offen offset:1024 sc1 lds
    s_waitcnt lgkmcnt(12)
    v_mfma_f32_32x32x16_bf16 v[60:75], v[196:199], v[228:231], v[60:75]
    ds_read_b64_tr_b16 v[180:181], v37 offset:26624
    ds_read_b64_tr_b16 v[182:183], v38 offset:26624
    ds_read_b64_tr_b16 v[212:213], v49 offset:20480
    ds_read_b64_tr_b16 v[214:215], v49 offset:20992
    s_waitcnt lgkmcnt(12)
    v_mfma_f32_32x32x16_bf16 v[60:75], v[200:203], v[232:235], v[60:75]
    ds_read_b64_tr_b16 v[184:185], v37 offset:27648
    ds_read_b64_tr_b16 v[186:187], v38 offset:27648
    ds_read_b64_tr_b16 v[216:217], v49 offset:22528
    ds_read_b64_tr_b16 v[218:219], v49 offset:23040
    s_add_u32 m0, s89, 106496
    s_add_u32 s82, s87, 45056
    buffer_load_dwordx4 v5, s[64:67], s82 offen offset:0 sc1 lds
    buffer_load_dwordx4 v5, s[64:67], s82 offen offset:1024 sc1 lds
    s_waitcnt lgkmcnt(12)
    v_mfma_f32_32x32x16_bf16 v[60:75], v[172:175], v[204:207], v[60:75]
    ds_read_b64_tr_b16 v[188:189], v37 offset:32768
    ds_read_b64_tr_b16 v[190:191], v38 offset:32768
    ds_read_b64_tr_b16 v[220:221], v49 offset:24576
    ds_read_b64_tr_b16 v[222:223], v49 offset:25088
    s_waitcnt lgkmcnt(12)
    v_mfma_f32_32x32x16_bf16 v[60:75], v[176:179], v[208:211], v[60:75]
    ds_read_b64_tr_b16 v[192:193], v37 offset:33792
    ds_read_b64_tr_b16 v[194:195], v38 offset:33792
    ds_read_b64_tr_b16 v[224:225], v49 offset:26624
    ds_read_b64_tr_b16 v[226:227], v49 offset:27136
    s_add_u32 m0, s89, 65536
    s_add_u32 s82, s87, 49152
    buffer_load_dwordx4 v5, s[64:67], s82 offen offset:0 sc1 lds
    buffer_load_dwordx4 v5, s[64:67], s82 offen offset:1024 sc1 lds
    s_waitcnt lgkmcnt(12)
    v_mfma_f32_32x32x16_bf16 v[60:75], v[180:183], v[212:215], v[60:75]
    ds_read_b64_tr_b16 v[196:197], v37 offset:34816
    ds_read_b64_tr_b16 v[198:199], v38 offset:34816
    ds_read_b64_tr_b16 v[228:229], v49 offset:28672
    ds_read_b64_tr_b16 v[230:231], v49 offset:29184
    s_waitcnt lgkmcnt(12)
    v_mfma_f32_32x32x16_bf16 v[60:75], v[184:187], v[216:219], v[60:75]
    ds_read_b64_tr_b16 v[200:201], v37 offset:35840
    ds_read_b64_tr_b16 v[202:203], v38 offset:35840
    ds_read_b64_tr_b16 v[232:233], v49 offset:30720
    ds_read_b64_tr_b16 v[234:235], v49 offset:31232
    s_add_u32 m0, s89, 114688
    s_mov_b32 s82, 786432
    buffer_load_dwordx4 v24, s[68:71], s82 offen offset:0 lds
    buffer_load_dwordx4 v25, s[68:71], s82 offen offset:1024 lds
    s_waitcnt vmcnt(14)
    s_waitcnt vmcnt(12)
    s_barrier
    s_waitcnt lgkmcnt(12)
    v_mfma_f32_32x32x16_bf16 v[60:75], v[188:191], v[220:223], v[60:75]
    ds_read_b64_tr_b16 v[172:173], v39 offset:32768
    ds_read_b64_tr_b16 v[174:175], v40 offset:32768
    ds_read_b64_tr_b16 v[204:205], v41 offset:0
    ds_read_b64_tr_b16 v[206:207], v41 offset:512
    s_waitcnt lgkmcnt(12)
    v_mfma_f32_32x32x16_bf16 v[60:75], v[192:195], v[224:227], v[60:75]
    ds_read_b64_tr_b16 v[176:177], v39 offset:33792
    ds_read_b64_tr_b16 v[178:179], v40 offset:33792
    ds_read_b64_tr_b16 v[208:209], v41 offset:2048
    ds_read_b64_tr_b16 v[210:211], v41 offset:2560
    s_add_u32 m0, s89, 73728
    s_add_u32 s82, s87, 53248
    buffer_load_dwordx4 v5, s[64:67], s82 offen offset:0 sc1 lds
    buffer_load_dwordx4 v5, s[64:67], s82 offen offset:1024 sc1 lds
    s_waitcnt lgkmcnt(12)
    v_mfma_f32_32x32x16_bf16 v[60:75], v[196:199], v[228:231], v[60:75]
    ds_read_b64_tr_b16 v[180:181], v39 offset:34816
    ds_read_b64_tr_b16 v[182:183], v40 offset:34816
    ds_read_b64_tr_b16 v[212:213], v41 offset:4096
    ds_read_b64_tr_b16 v[214:215], v41 offset:4608
    s_waitcnt lgkmcnt(12)
    v_mfma_f32_32x32x16_bf16 v[60:75], v[200:203], v[232:235], v[60:75]
    ds_read_b64_tr_b16 v[184:185], v39 offset:35840
    ds_read_b64_tr_b16 v[186:187], v40 offset:35840
    ds_read_b64_tr_b16 v[216:217], v41 offset:6144
    ds_read_b64_tr_b16 v[218:219], v41 offset:6656
    s_add_u32 m0, s89, 122880
    s_mov_b32 s82, 851968
    buffer_load_dwordx4 v24, s[68:71], s82 offen offset:0 lds
    buffer_load_dwordx4 v25, s[68:71], s82 offen offset:1024 lds
    s_waitcnt lgkmcnt(12)
    v_mfma_f32_32x32x16_bf16 v[60:75], v[172:175], v[204:207], v[60:75]
    ds_read_b64_tr_b16 v[188:189], v39 offset:40960
    ds_read_b64_tr_b16 v[190:191], v40 offset:40960
    ds_read_b64_tr_b16 v[220:221], v41 offset:8192
    ds_read_b64_tr_b16 v[222:223], v41 offset:8704
    s_waitcnt lgkmcnt(12)
    v_mfma_f32_32x32x16_bf16 v[60:75], v[176:179], v[208:211], v[60:75]
    ds_read_b64_tr_b16 v[192:193], v39 offset:41984
    ds_read_b64_tr_b16 v[194:195], v40 offset:41984
    ds_read_b64_tr_b16 v[224:225], v41 offset:10240
    ds_read_b64_tr_b16 v[226:227], v41 offset:10752
    s_add_u32 m0, s89, 81920
    s_add_u32 s82, s87, 57344
    buffer_load_dwordx4 v5, s[64:67], s82 offen offset:0 sc1 lds
    buffer_load_dwordx4 v5, s[64:67], s82 offen offset:1024 sc1 lds
    s_waitcnt lgkmcnt(12)
    v_mfma_f32_32x32x16_bf16 v[60:75], v[180:183], v[212:215], v[60:75]
    ds_read_b64_tr_b16 v[196:197], v39 offset:43008
    ds_read_b64_tr_b16 v[198:199], v40 offset:43008
    ds_read_b64_tr_b16 v[228:229], v41 offset:12288
    ds_read_b64_tr_b16 v[230:231], v41 offset:12800
    s_waitcnt lgkmcnt(12)
    v_mfma_f32_32x32x16_bf16 v[60:75], v[184:187], v[216:219], v[60:75]
    ds_read_b64_tr_b16 v[200:201], v39 offset:44032
    ds_read_b64_tr_b16 v[202:203], v40 offset:44032
    ds_read_b64_tr_b16 v[232:233], v41 offset:14336
    ds_read_b64_tr_b16 v[234:235], v41 offset:14848
    s_add_u32 m0, s89, 131072
    s_mov_b32 s82, 917504
    buffer_load_dwordx4 v24, s[68:71], s82 offen offset:0 lds
    buffer_load_dwordx4 v25, s[68:71], s82 offen offset:1024 lds
    s_waitcnt vmcnt(18)
    s_waitcnt vmcnt(16)
    s_barrier
    s_waitcnt lgkmcnt(12)
    v_mfma_f32_32x32x16_bf16 v[60:75], v[188:191], v[220:223], v[60:75]
    ds_read_b64_tr_b16 v[172:173], v35 offset:49152
    ds_read_b64_tr_b16 v[174:175], v36 offset:49152
    ds_read_b64_tr_b16 v[204:205], v41 offset:16384
    ds_read_b64_tr_b16 v[206:207], v41 offset:16896
    s_waitcnt lgkmcnt(12)
    v_mfma_f32_32x32x16_bf16 v[60:75], v[192:195], v[224:227], v[60:75]
    ds_read_b64_tr_b16 v[176:177], v35 offset:50176
    ds_read_b64_tr_b16 v[178:179], v36 offset:50176
    ds_read_b64_tr_b16 v[208:209], v41 offset:18432
    ds_read_b64_tr_b16 v[210:211], v41 offset:18944
    s_add_u32 m0, s89, 90112
    s_add_u32 s82, s87, 61440
    buffer_load_dwordx4 v5, s[64:67], s82 offen offset:0 sc1 lds
    buffer_load_dwordx4 v5, s[64:67], s82 offen offset:1024 sc1 lds
    s_waitcnt lgkmcnt(12)
    v_mfma_f32_32x32x16_bf16 v[60:75], v[196:199], v[228:231], v[60:75]
    ds_read_b64_tr_b16 v[180:181], v35 offset:51200
    ds_read_b64_tr_b16 v[182:183], v36 offset:51200
    ds_read_b64_tr_b16 v[212:213], v41 offset:20480
    ds_read_b64_tr_b16 v[214:215], v41 offset:20992
    s_waitcnt lgkmcnt(12)
    v_mfma_f32_32x32x16_bf16 v[60:75], v[200:203], v[232:235], v[60:75]
    ds_read_b64_tr_b16 v[184:185], v35 offset:52224
    ds_read_b64_tr_b16 v[186:187], v36 offset:52224
    ds_read_b64_tr_b16 v[216:217], v41 offset:22528
    ds_read_b64_tr_b16 v[218:219], v41 offset:23040
    s_add_u32 m0, s89, 139264
    s_mov_b32 s82, 983040
    buffer_load_dwordx4 v24, s[68:71], s82 offen offset:0 lds
    buffer_load_dwordx4 v25, s[68:71], s82 offen offset:1024 lds
    s_waitcnt lgkmcnt(12)
    v_mfma_f32_32x32x16_bf16 v[60:75], v[172:175], v[204:207], v[60:75]
    ds_read_b64_tr_b16 v[188:189], v37 offset:40960
    ds_read_b64_tr_b16 v[190:191], v38 offset:40960
    ds_read_b64_tr_b16 v[220:221], v41 offset:24576
    ds_read_b64_tr_b16 v[222:223], v41 offset:25088
    s_waitcnt lgkmcnt(12)
    v_mfma_f32_32x32x16_bf16 v[60:75], v[176:179], v[208:211], v[60:75]
    ds_read_b64_tr_b16 v[192:193], v37 offset:41984
    ds_read_b64_tr_b16 v[194:195], v38 offset:41984
    ds_read_b64_tr_b16 v[224:225], v41 offset:26624
    ds_read_b64_tr_b16 v[226:227], v41 offset:27136
    s_add_u32 m0, s89, 147456
    s_add_u32 s82, s87, 65536
    buffer_load_dwordx4 v5, s[64:67], s82 offen offset:0 sc1 lds
    buffer_load_dwordx4 v5, s[64:67], s82 offen offset:1024 sc1 lds
    s_waitcnt lgkmcnt(12)
    v_mfma_f32_32x32x16_bf16 v[60:75], v[180:183], v[212:215], v[60:75]
    ds_read_b64_tr_b16 v[196:197], v37 offset:43008
    ds_read_b64_tr_b16 v[198:199], v38 offset:43008
    ds_read_b64_tr_b16 v[228:229], v41 offset:28672
    ds_read_b64_tr_b16 v[230:231], v41 offset:29184
    s_waitcnt lgkmcnt(12)
    v_mfma_f32_32x32x16_bf16 v[60:75], v[184:187], v[216:219], v[60:75]
    ds_read_b64_tr_b16 v[200:201], v37 offset:44032
    ds_read_b64_tr_b16 v[202:203], v38 offset:44032
    ds_read_b64_tr_b16 v[232:233], v41 offset:30720
    ds_read_b64_tr_b16 v[234:235], v41 offset:31232
    s_add_u32 m0, s89, 0
    s_mov_b32 s82, 1048576
    buffer_load_dwordx4 v24, s[68:71], s82 offen offset:0 lds
    buffer_load_dwordx4 v25, s[68:71], s82 offen offset:1024 lds
    s_waitcnt vmcnt(22)
    s_waitcnt vmcnt(20)
    s_barrier
    s_waitcnt lgkmcnt(12)
    v_mfma_f32_32x32x16_bf16 v[60:75], v[188:191], v[220:223], v[60:75]
    ds_read_b64_tr_b16 v[172:173], v37 offset:0
    ds_read_b64_tr_b16 v[174:175], v38 offset:0
    ds_read_b64_tr_b16 v[204:205], v41 offset:32768
    ds_read_b64_tr_b16 v[206:207], v41 offset:33280
    s_waitcnt lgkmcnt(12)
    v_mfma_f32_32x32x16_bf16 v[60:75], v[192:195], v[224:227], v[60:75]
    ds_read_b64_tr_b16 v[176:177], v37 offset:1024
    ds_read_b64_tr_b16 v[178:179], v38 offset:1024
    ds_read_b64_tr_b16 v[208:209], v41 offset:34816
    ds_read_b64_tr_b16 v[210:211], v41 offset:35328
    s_add_u32 m0, s89, 155648
    s_add_u32 s82, s87, 69632
    buffer_load_dwordx4 v5, s[64:67], s82 offen offset:0 sc1 lds
    buffer_load_dwordx4 v5, s[64:67], s82 offen offset:1024 sc1 lds
    s_waitcnt lgkmcnt(12)
    v_mfma_f32_32x32x16_bf16 v[60:75], v[196:199], v[228:231], v[60:75]
    ds_read_b64_tr_b16 v[180:181], v37 offset:2048
    ds_read_b64_tr_b16 v[182:183], v38 offset:2048
    ds_read_b64_tr_b16 v[212:213], v41 offset:36864
    ds_read_b64_tr_b16 v[214:215], v41 offset:37376
    s_waitcnt lgkmcnt(12)
    v_mfma_f32_32x32x16_bf16 v[60:75], v[200:203], v[232:235], v[60:75]
    ds_read_b64_tr_b16 v[184:185], v37 offset:3072
    ds_read_b64_tr_b16 v[186:187], v38 offset:3072
    ds_read_b64_tr_b16 v[216:217], v41 offset:38912
    ds_read_b64_tr_b16 v[218:219], v41 offset:39424
    s_add_u32 m0, s89, 8192
    s_mov_b32 s82, 1114112
    buffer_load_dwordx4 v24, s[68:71], s82 offen offset:0 lds
    buffer_load_dwordx4 v25, s[68:71], s82 offen offset:1024 lds
    s_waitcnt lgkmcnt(12)
    v_mfma_f32_32x32x16_bf16 v[60:75], v[172:175], v[204:207], v[60:75]
    ds_read_b64_tr_b16 v[188:189], v37 offset:49152
    ds_read_b64_tr_b16 v[190:191], v38 offset:49152
    ds_read_b64_tr_b16 v[220:221], v41 offset:40960
    ds_read_b64_tr_b16 v[222:223], v41 offset:41472
    s_waitcnt lgkmcnt(12)
    v_mfma_f32_32x32x16_bf16 v[60:75], v[176:179], v[208:211], v[60:75]
    ds_read_b64_tr_b16 v[192:193], v37 offset:50176
    ds_read_b64_tr_b16 v[194:195], v38 offset:50176
    ds_read_b64_tr_b16 v[224:225], v41 offset:43008
    ds_read_b64_tr_b16 v[226:227], v41 offset:43520
    s_add_u32 m0, s89, 49152
    s_add_u32 s82, s87, 73728
    buffer_load_dwordx4 v5, s[64:67], s82 offen offset:0 sc1 lds
    buffer_load_dwordx4 v5, s[64:67], s82 offen offset:1024 sc1 lds
    s_waitcnt lgkmcnt(12)
    v_mfma_f32_32x32x16_bf16 v[60:75], v[180:183], v[212:215], v[60:75]
    ds_read_b64_tr_b16 v[196:197], v37 offset:51200
    ds_read_b64_tr_b16 v[198:199], v38 offset:51200
    ds_read_b64_tr_b16 v[228:229], v41 offset:45056
    ds_read_b64_tr_b16 v[230:231], v41 offset:45568
    s_waitcnt lgkmcnt(12)
    v_mfma_f32_32x32x16_bf16 v[60:75], v[184:187], v[216:219], v[60:75]
    ds_read_b64_tr_b16 v[200:201], v37 offset:52224
    ds_read_b64_tr_b16 v[202:203], v38 offset:52224
    ds_read_b64_tr_b16 v[232:233], v41 offset:47104
    ds_read_b64_tr_b16 v[234:235], v41 offset:47616
    s_add_u32 m0, s89, 16384
    s_mov_b32 s82, 1179648
    buffer_load_dwordx4 v24, s[68:71], s82 offen offset:0 lds
    buffer_load_dwordx4 v25, s[68:71], s82 offen offset:1024 lds
    s_waitcnt vmcnt(26)
    s_waitcnt vmcnt(24)
    s_waitcnt vmcnt(22)
    s_waitcnt vmcnt(20)
    s_barrier
    s_waitcnt lgkmcnt(12)
    v_mfma_f32_32x32x16_bf16 v[60:75], v[188:191], v[220:223], v[60:75]
    ds_read_b64_tr_b16 v[172:173], v37 offset:8192
    ds_read_b64_tr_b16 v[174:175], v38 offset:8192
    ds_read_b64_tr_b16 v[204:205], v49 offset:0
    ds_read_b64_tr_b16 v[206:207], v49 offset:512
    s_waitcnt lgkmcnt(12)
    v_mfma_f32_32x32x16_bf16 v[60:75], v[192:195], v[224:227], v[60:75]
    ds_read_b64_tr_b16 v[176:177], v37 offset:9216
    ds_read_b64_tr_b16 v[178:179], v38 offset:9216
    ds_read_b64_tr_b16 v[208:209], v49 offset:2048
    ds_read_b64_tr_b16 v[210:211], v49 offset:2560
    s_add_u32 m0, s89, 98304
    s_add_u32 s82, s87, 77824
    buffer_load_dwordx4 v5, s[64:67], s82 offen offset:0 sc1 lds
    buffer_load_dwordx4 v5, s[64:67], s82 offen offset:1024 sc1 lds
    s_waitcnt lgkmcnt(12)
    v_mfma_f32_32x32x16_bf16 v[60:75], v[196:199], v[228:231], v[60:75]
    ds_read_b64_tr_b16 v[180:181], v37 offset:10240
    ds_read_b64_tr_b16 v[182:183], v38 offset:10240
    ds_read_b64_tr_b16 v[212:213], v49 offset:4096
    ds_read_b64_tr_b16 v[214:215], v49 offset:4608
    s_waitcnt lgkmcnt(12)
    v_mfma_f32_32x32x16_bf16 v[60:75], v[200:203], v[232:235], v[60:75]
    ds_read_b64_tr_b16 v[184:185], v37 offset:11264
    ds_read_b64_tr_b16 v[186:187], v38 offset:11264
    ds_read_b64_tr_b16 v[216:217], v49 offset:6144
    ds_read_b64_tr_b16 v[218:219], v49 offset:6656
    s_add_u32 m0, s89, 24576
    s_mov_b32 s82, 1245184
    buffer_load_dwordx4 v24, s[68:71], s82 offen offset:0 lds
    buffer_load_dwordx4 v25, s[68:71], s82 offen offset:1024 lds
    s_waitcnt lgkmcnt(12)
    v_mfma_f32_32x32x16_bf16 v[60:75], v[172:175], v[204:207], v[60:75]
    ds_read_b64_tr_b16 v[188:189], v37 offset:16384
    ds_read_b64_tr_b16 v[190:191], v38 offset:16384
    ds_read_b64_tr_b16 v[220:221], v49 offset:8192
    ds_read_b64_tr_b16 v[222:223], v49 offset:8704
    s_waitcnt lgkmcnt(12)
    v_mfma_f32_32x32x16_bf16 v[60:75], v[176:179], v[208:211], v[60:75]
    ds_read_b64_tr_b16 v[192:193], v37 offset:17408
    ds_read_b64_tr_b16 v[194:195], v38 offset:17408
    ds_read_b64_tr_b16 v[224:225], v49 offset:10240
    ds_read_b64_tr_b16 v[226:227], v49 offset:10752
    s_add_u32 m0, s89, 57344
    s_add_u32 s82, s87, 81920
    buffer_load_dwordx4 v5, s[64:67], s82 offen offset:0 sc1 lds
    buffer_load_dwordx4 v5, s[64:67], s82 offen offset:1024 sc1 lds
    s_waitcnt lgkmcnt(12)
    v_mfma_f32_32x32x16_bf16 v[60:75], v[180:183], v[212:215], v[60:75]
    ds_read_b64_tr_b16 v[196:197], v37 offset:18432
    ds_read_b64_tr_b16 v[198:199], v38 offset:18432
    ds_read_b64_tr_b16 v[228:229], v49 offset:12288
    ds_read_b64_tr_b16 v[230:231], v49 offset:12800
    s_waitcnt lgkmcnt(12)
    v_mfma_f32_32x32x16_bf16 v[60:75], v[184:187], v[216:219], v[60:75]
    ds_read_b64_tr_b16 v[200:201], v37 offset:19456
    ds_read_b64_tr_b16 v[202:203], v38 offset:19456
    ds_read_b64_tr_b16 v[232:233], v49 offset:14336
    ds_read_b64_tr_b16 v[234:235], v49 offset:14848
    s_add_u32 m0, s89, 32768
    s_mov_b32 s82, 1310720
    buffer_load_dwordx4 v24, s[68:71], s82 offen offset:0 lds
    buffer_load_dwordx4 v25, s[68:71], s82 offen offset:1024 lds
    s_waitcnt vmcnt(26)
    s_waitcnt vmcnt(24)
    s_waitcnt vmcnt(22)
    s_waitcnt vmcnt(20)
    s_barrier
    s_waitcnt lgkmcnt(12)
    v_mfma_f32_32x32x16_bf16 v[60:75], v[188:191], v[220:223], v[60:75]
    ds_read_b64_tr_b16 v[172:173], v37 offset:24576
    ds_read_b64_tr_b16 v[174:175], v38 offset:24576
    ds_read_b64_tr_b16 v[204:205], v49 offset:16384
    ds_read_b64_tr_b16 v[206:207], v49 offset:16896
    s_waitcnt lgkmcnt(12)
    v_mfma_f32_32x32x16_bf16 v[60:75], v[192:195], v[224:227], v[60:75]
    ds_read_b64_tr_b16 v[176:177], v37 offset:25600
    ds_read_b64_tr_b16 v[178:179], v38 offset:25600
    ds_read_b64_tr_b16 v[208:209], v49 offset:18432
    ds_read_b64_tr_b16 v[210:211], v49 offset:18944
    s_add_u32 m0, s89, 106496
    s_add_u32 s82, s87, 86016
    buffer_load_dwordx4 v5, s[64:67], s82 offen offset:0 sc1 lds
    buffer_load_dwordx4 v5, s[64:67], s82 offen offset:1024 sc1 lds
    s_waitcnt lgkmcnt(12)
    v_mfma_f32_32x32x16_bf16 v[60:75], v[196:199], v[228:231], v[60:75]
    ds_read_b64_tr_b16 v[180:181], v37 offset:26624
    ds_read_b64_tr_b16 v[182:183], v38 offset:26624
    ds_read_b64_tr_b16 v[212:213], v49 offset:20480
    ds_read_b64_tr_b16 v[214:215], v49 offset:20992
    s_waitcnt lgkmcnt(12)
    v_mfma_f32_32x32x16_bf16 v[60:75], v[200:203], v[232:235], v[60:75]
    ds_read_b64_tr_b16 v[184:185], v37 offset:27648
    ds_read_b64_tr_b16 v[186:187], v38 offset:27648
    ds_read_b64_tr_b16 v[216:217], v49 offset:22528
    ds_read_b64_tr_b16 v[218:219], v49 offset:23040
    s_add_u32 m0, s89, 40960
    s_mov_b32 s82, 1376256
    buffer_load_dwordx4 v24, s[68:71], s82 offen offset:0 lds
    buffer_load_dwordx4 v25, s[68:71], s82 offen offset:1024 lds
    s_cmp_eq_u32 s73, 0
    s_cbranch_scc0 L_g213
    buffer_load_dwordx2 v[22:23], v20, s[64:67], s91 offen sc0 sc1
L_g213:
    s_waitcnt lgkmcnt(12)
    v_mfma_f32_32x32x16_bf16 v[60:75], v[172:175], v[204:207], v[60:75]
    ds_read_b64_tr_b16 v[188:189], v37 offset:32768
    ds_read_b64_tr_b16 v[190:191], v38 offset:32768
    ds_read_b64_tr_b16 v[220:221], v49 offset:24576
    ds_read_b64_tr_b16 v[222:223], v49 offset:25088
    s_waitcnt lgkmcnt(12)
    v_mfma_f32_32x32x16_bf16 v[60:75], v[176:179], v[208:211], v[60:75]
    ds_read_b64_tr_b16 v[192:193], v37 offset:33792
    ds_read_b64_tr_b16 v[194:195], v38 offset:33792
    ds_read_b64_tr_b16 v[224:225], v49 offset:26624
    ds_read_b64_tr_b16 v[226:227], v49 offset:27136
    s_add_u32 m0, s89, 65536
    s_movk_i32 s82, 0
    buffer_load_dwordx4 v26, s[52:55], s82 offen offset:0 lds
    buffer_load_dwordx4 v27, s[52:55], s82 offen offset:1024 lds
    s_waitcnt lgkmcnt(12)
    v_mfma_f32_32x32x16_bf16 v[60:75], v[180:183], v[212:215], v[60:75]
    ds_read_b64_tr_b16 v[196:197], v37 offset:34816
    ds_read_b64_tr_b16 v[198:199], v38 offset:34816
    ds_read_b64_tr_b16 v[228:229], v49 offset:28672
    ds_read_b64_tr_b16 v[230:231], v49 offset:29184
    s_waitcnt lgkmcnt(12)
    v_mfma_f32_32x32x16_bf16 v[60:75], v[184:187], v[216:219], v[60:75]
    ds_read_b64_tr_b16 v[200:201], v37 offset:35840
    ds_read_b64_tr_b16 v[202:203], v38 offset:35840
    ds_read_b64_tr_b16 v[232:233], v49 offset:30720
    ds_read_b64_tr_b16 v[234:235], v49 offset:31232
    s_add_u32 m0, s89, 114688
    s_movk_i32 s82, 0
    buffer_load_dwordx4 v26, s[56:59], s82 offen offset:0 lds
    buffer_load_dwordx4 v27, s[56:59], s82 offen offset:1024 lds
    s_waitcnt vmcnt(26)
    s_waitcnt vmcnt(24)
    s_waitcnt vmcnt(22)
    s_waitcnt vmcnt(20)
    s_barrier
    s_waitcnt lgkmcnt(12)
    v_mfma_f32_32x32x16_bf16 v[60:75], v[188:191], v[220:223], v[60:75]
    ds_read_b64_tr_b16 v[172:173], v39 offset:32768
    ds_read_b64_tr_b16 v[174:175], v40 offset:32768
    ds_read_b64_tr_b16 v[204:205], v41 offset:0
    ds_read_b64_tr_b16 v[206:207], v41 offset:512
    s_waitcnt lgkmcnt(12)
    v_mfma_f32_32x32x16_bf16 v[60:75], v[192:195], v[224:227], v[60:75]
    ds_read_b64_tr_b16 v[176:177], v39 offset:33792
    ds_read_b64_tr_b16 v[178:179], v40 offset:33792
    ds_read_b64_tr_b16 v[208:209], v41 offset:2048
    ds_read_b64_tr_b16 v[210:211], v41 offset:2560
    s_add_u32 m0, s89, 73728
    s_movk_i32 s82, 128
    buffer_load_dwordx4 v26, s[52:55], s82 offen offset:0 lds
    buffer_load_dwordx4 v27, s[52:55], s82 offen offset:1024 lds
    s_waitcnt lgkmcnt(12)
    v_mfma_f32_32x32x16_bf16 v[60:75], v[196:199], v[228:231], v[60:75]
    ds_read_b64_tr_b16 v[180:181], v39 offset:34816
    ds_read_b64_tr_b16 v[182:183], v40 offset:34816
    ds_read_b64_tr_b16 v[212:213], v41 offset:4096
    ds_read_b64_tr_b16 v[214:215], v41 offset:4608
    s_waitcnt lgkmcnt(12)
    v_mfma_f32_32x32x16_bf16 v[60:75], v[200:203], v[232:235], v[60:75]
    ds_read_b64_tr_b16 v[184:185], v39 offset:35840
    ds_read_b64_tr_b16 v[186:187], v40 offset:35840
    ds_read_b64_tr_b16 v[216:217], v41 offset:6144
    ds_read_b64_tr_b16 v[218:219], v41 offset:6656
    s_add_u32 m0, s89, 122880
    s_movk_i32 s82, 128
    buffer_load_dwordx4 v26, s[56:59], s82 offen offset:0 lds
    buffer_load_dwordx4 v27, s[56:59], s82 offen offset:1024 lds
    s_waitcnt lgkmcnt(12)
    v_mfma_f32_32x32x16_bf16 v[60:75], v[172:175], v[204:207], v[60:75]
    ds_read_b64_tr_b16 v[188:189], v39 offset:40960
    ds_read_b64_tr_b16 v[190:191], v40 offset:40960
    ds_read_b64_tr_b16 v[220:221], v41 offset:8192
    ds_read_b64_tr_b16 v[222:223], v41 offset:8704
    s_waitcnt lgkmcnt(12)
    v_mfma_f32_32x32x16_bf16 v[60:75], v[176:179], v[208:211], v[60:75]
    ds_read_b64_tr_b16 v[192:193], v39 offset:41984
    ds_read_b64_tr_b16 v[194:195], v40 offset:41984
    ds_read_b64_tr_b16 v[224:225], v41 offset:10240
    ds_read_b64_tr_b16 v[226:227], v41 offset:10752
    s_add_u32 m0, s89, 81920
    s_movk_i32 s82, 256
    buffer_load_dwordx4 v26, s[52:55], s82 offen offset:0 lds
    buffer_load_dwordx4 v27, s[52:55], s82 offen offset:1024 lds
    s_waitcnt lgkmcnt(12)
    v_mfma_f32_32x32x16_bf16 v[60:75], v[180:183], v[212:215], v[60:75]
    ds_read_b64_tr_b16 v[196:197], v39 offset:43008
    ds_read_b64_tr_b16 v[198:199], v40 offset:43008
    ds_read_b64_tr_b16 v[228:229], v41 offset:12288
    ds_read_b64_tr_b16 v[230:231], v41 offset:12800
    s_waitcnt lgkmcnt(12)
    v_mfma_f32_32x32x16_bf16 v[60:75], v[184:187], v[216:219], v[60:75]
    ds_read_b64_tr_b16 v[200:201], v39 offset:44032
    ds_read_b64_tr_b16 v[202:203], v40 offset:44032
    ds_read_b64_tr_b16 v[232:233], v41 offset:14336
    ds_read_b64_tr_b16 v[234:235], v41 offset:14848
    s_add_u32 m0, s89, 131072
    s_movk_i32 s82, 256
    buffer_load_dwordx4 v26, s[56:59], s82 offen offset:0 lds
    buffer_load_dwordx4 v27, s[56:59], s82 offen offset:1024 lds
    s_cmp_eq_u32 s73, 0
    s_cbranch_scc0 L_g216
    s_waitcnt vmcnt(12)
    v_cmp_ne_u64 vcc, s[46:47], v[22:23]
    s_nop 0
    s_mov_b64 s[4:5], vcc
    s_cmp_eq_u64 s[4:5], 0
    s_cbranch_scc1 L_f2_ok
L_f2_retry:
    s_add_u32 s3, s3, 1
    s_cmp_gt_u32 s3, 1048576
    s_cbranch_scc1 L_f2_ok
    s_sleep 2
    buffer_load_dwordx2 v[22:23], v20, s[64:67], s91 offen sc0 sc1
    s_waitcnt vmcnt(0)
    v_cmp_ne_u64 vcc, s[46:47], v[22:23]
    s_nop 1
    s_mov_b64 s[4:5], vcc
    s_cmp_eq_u64 s[4:5], 0
    s_cbranch_scc0 L_f2_retry
L_f2_ok:
L_g216:
    s_waitcnt vmcnt(26)
    s_waitcnt vmcnt(24)
    s_waitcnt vmcnt(22)
    s_waitcnt vmcnt(20)
    s_barrier
    s_waitcnt lgkmcnt(12)
    v_mfma_f32_32x32x16_bf16 v[60:75], v[188:191], v[220:223], v[60:75]
    ds_read_b64_tr_b16 v[172:173], v35 offset:49152
    ds_read_b64_tr_b16 v[174:175], v36 offset:49152
    ds_read_b64_tr_b16 v[204:205], v41 offset:16384
    ds_read_b64_tr_b16 v[206:207], v41 offset:16896
    s_waitcnt lgkmcnt(12)
    v_mfma_f32_32x32x16_bf16 v[60:75], v[192:195], v[224:227], v[60:75]
    ds_read_b64_tr_b16 v[176:177], v35 offset:50176
    ds_read_b64_tr_b16 v[178:179], v36 offset:50176
    ds_read_b64_tr_b16 v[208:209], v41 offset:18432
    ds_read_b64_tr_b16 v[210:211], v41 offset:18944
    s_add_u32 m0, s89, 90112
    s_add_u32 s82, s88, 0
    buffer_load_dwordx4 v5, s[64:67], s82 offen offset:0 sc1 lds
    buffer_load_dwordx4 v5, s[64:67], s82 offen offset:1024 sc1 lds
    s_waitcnt lgkmcnt(12)
    v_mfma_f32_32x32x16_bf16 v[60:75], v[196:199], v[228:231], v[60:75]
    ds_read_b64_tr_b16 v[180:181], v35 offset:51200
    ds_read_b64_tr_b16 v[182:183], v36 offset:51200
    ds_read_b64_tr_b16 v[212:213], v41 offset:20480
    ds_read_b64_tr_b16 v[214:215], v41 offset:20992
    s_waitcnt lgkmcnt(12)
    v_mfma_f32_32x32x16_bf16 v[60:75], v[200:203], v[232:235], v[60:75]
    ds_read_b64_tr_b16 v[184:185], v35 offset:52224
    ds_read_b64_tr_b16 v[186:187], v36 offset:52224
    ds_read_b64_tr_b16 v[216:217], v41 offset:22528
    ds_read_b64_tr_b16 v[218:219], v41 offset:23040
    s_add_u32 m0, s89, 139264
    s_add_u32 s82, s88, 2048
    buffer_load_dwordx4 v5, s[64:67], s82 offen offset:0 sc1 lds
    buffer_load_dwordx4 v5, s[64:67], s82 offen offset:1024 sc1 lds
    s_waitcnt lgkmcnt(12)
    v_mfma_f32_32x32x16_bf16 v[60:75], v[172:175], v[204:207], v[60:75]
    ds_read_b64_tr_b16 v[188:189], v37 offset:40960
    ds_read_b64_tr_b16 v[190:191], v38 offset:40960
    ds_read_b64_tr_b16 v[220:221], v41 offset:24576
    ds_read_b64_tr_b16 v[222:223], v41 offset:25088
    s_waitcnt lgkmcnt(12)
    v_mfma_f32_32x32x16_bf16 v[60:75], v[176:179], v[208:211], v[60:75]
    ds_read_b64_tr_b16 v[192:193], v37 offset:41984
    ds_read_b64_tr_b16 v[194:195], v38 offset:41984
    ds_read_b64_tr_b16 v[224:225], v41 offset:26624
    ds_read_b64_tr_b16 v[226:227], v41 offset:27136
    s_add_u32 m0, s89, 147456
    s_add_u32 s82, s88, 8192
    buffer_load_dwordx4 v5, s[64:67], s82 offen offset:0 sc1 lds
    buffer_load_dwordx4 v5, s[64:67], s82 offen offset:1024 sc1 lds
    s_waitcnt lgkmcnt(12)
    v_mfma_f32_32x32x16_bf16 v[60:75], v[180:183], v[212:215], v[60:75]
    ds_read_b64_tr_b16 v[196:197], v37 offset:43008
    ds_read_b64_tr_b16 v[198:199], v38 offset:43008
    ds_read_b64_tr_b16 v[228:229], v41 offset:28672
    ds_read_b64_tr_b16 v[230:231], v41 offset:29184
    s_waitcnt lgkmcnt(12)
    v_mfma_f32_32x32x16_bf16 v[60:75], v[184:187], v[216:219], v[60:75]
    ds_read_b64_tr_b16 v[200:201], v37 offset:44032
    ds_read_b64_tr_b16 v[202:203], v38 offset:44032
    ds_read_b64_tr_b16 v[232:233], v41 offset:30720
    ds_read_b64_tr_b16 v[234:235], v41 offset:31232
    s_add_u32 m0, s89, 0
    s_add_u32 s82, s88, 10240
    buffer_load_dwordx4 v5, s[64:67], s82 offen offset:0 sc1 lds
    buffer_load_dwordx4 v5, s[64:67], s82 offen offset:1024 sc1 lds
    s_waitcnt vmcnt(26)
    s_waitcnt vmcnt(24)
    s_waitcnt vmcnt(22)
    s_waitcnt vmcnt(20)
    s_barrier
    s_waitcnt lgkmcnt(12)
    v_mfma_f32_32x32x16_bf16 v[60:75], v[188:191], v[220:223], v[60:75]
    ds_read_b64_tr_b16 v[172:173], v37 offset:0
    ds_read_b64_tr_b16 v[174:175], v38 offset:0
    ds_read_b64_tr_b16 v[204:205], v41 offset:32768
    ds_read_b64_tr_b16 v[206:207], v41 offset:33280
    s_waitcnt lgkmcnt(12)
    v_mfma_f32_32x32x16_bf16 v[60:75], v[192:195], v[224:227], v[60:75]
    ds_read_b64_tr_b16 v[176:177], v37 offset:1024
    ds_read_b64_tr_b16 v[178:179], v38 offset:1024
    ds_read_b64_tr_b16 v[208:209], v41 offset:34816
    ds_read_b64_tr_b16 v[210:211], v41 offset:35328
    s_add_u32 m0, s89, 155648
    s_add_u32 s82, s88, 16384
    buffer_load_dwordx4 v5, s[64:67], s82 offen offset:0 sc1 lds
    buffer_load_dwordx4 v5, s[64:67], s82 offen offset:1024 sc1 lds
    s_waitcnt lgkmcnt(12)
    v_mfma_f32_32x32x16_bf16 v[60:75], v[196:199], v[228:231], v[60:75]
    ds_read_b64_tr_b16 v[180:181], v37 offset:2048
    ds_read_b64_tr_b16 v[182:183], v38 offset:2048
    ds_read_b64_tr_b16 v[212:213], v41 offset:36864
    ds_read_b64_tr_b16 v[214:215], v41 offset:37376
    s_waitcnt lgkmcnt(12)
    v_mfma_f32_32x32x16_bf16 v[60:75], v[200:203], v[232:235], v[60:75]
    ds_read_b64_tr_b16 v[184:185], v37 offset:3072
    ds_read_b64_tr_b16 v[186:187], v38 offset:3072
    ds_read_b64_tr_b16 v[216:217], v41 offset:38912
    ds_read_b64_tr_b16 v[218:219], v41 offset:39424
    s_add_u32 m0, s89, 8192
    s_add_u32 s82, s88, 18432
    buffer_load_dwordx4 v5, s[64:67], s82 offen offset:0 sc1 lds
    buffer_load_dwordx4 v5, s[64:67], s82 offen offset:1024 sc1 lds
    s_waitcnt lgkmcnt(12)
    v_mfma_f32_32x32x16_bf16 v[60:75], v[172:175], v[204:207], v[60:75]
    ds_read_b64_tr_b16 v[188:189], v37 offset:49152
    ds_read_b64_tr_b16 v[190:191], v38 offset:49152
    s_waitcnt lgkmcnt(10)
    v_mfma_f32_32x32x16_bf16 v[60:75], v[176:179], v[208:211], v[60:75]
    ds_read_b64_tr_b16 v[220:221], v41 offset:40960
    ds_read_b64_tr_b16 v[222:223], v41 offset:41472
    s_add_u32 m0, s89, 49152
    s_add_u32 s82, s88, 24576
    buffer_load_dwordx4 v5, s[64:67], s82 offen offset:0 sc1 lds
    buffer_load_dwordx4 v5, s[64:67], s82 offen offset:1024 sc1 lds
    s_waitcnt lgkmcnt(8)
    v_mfma_f32_32x32x16_bf16 v[60:75], v[180:183], v[212:215], v[60:75]
    ds_read_b64_tr_b16 v[192:193], v37 offset:50176
    ds_read_b64_tr_b16 v[194:195], v38 offset:50176
    s_waitcnt lgkmcnt(6)
    v_mfma_f32_32x32x16_bf16 v[60:75], v[184:187], v[216:219], v[60:75]
    ds_read_b64_tr_b16 v[224:225], v41 offset:43008
    ds_read_b64_tr_b16 v[226:227], v41 offset:43520
    s_add_u32 m0, s89, 16384
    s_movk_i32 s82, 384
    buffer_load_dwordx4 v26, s[52:55], s82 offen offset:0 lds
    buffer_load_dwordx4 v27, s[52:55], s82 offen offset:1024 lds
    s_waitcnt vmcnt(14)
    s_waitcnt vmcnt(12)
    s_barrier
    s_waitcnt lgkmcnt(4)
    v_mfma_f32_32x32x16_bf16 v[60:75], v[188:191], v[220:223], v[60:75]
    v_add_u32 v41, 0, v31
    v_add_u32 v42, 0, v32
    v_add_u32 v43, 0, v33
    v_add_u32 v44, 0, v34
    v_add_u32 v45, 57344, v31
    v_add_u32 v46, 57344, v32
    v_add_u32 v47, 57344, v33
    v_add_u32 v48, 57344, v34
    v_add_u32 v49, 114688, v31
    v_add_u32 v50, 114688, v32
    v_add_u32 v51, 114688, v33
    v_add_u32 v52, 114688, v34
    s_add_u32 m0, s89, 98304
    s_add_u32 s82, s88, 26624
    buffer_load_dwordx4 v5, s[64:67], s82 offen offset:0 sc1 lds
    buffer_load_dwordx4 v5, s[64:67], s82 offen offset:1024 sc1 lds
    s_waitcnt lgkmcnt(0)
    v_mfma_f32_32x32x16_bf16 v[60:75], v[192:195], v[224:227], v[60:75]
    ds_read_b64_tr_b16 v[172:173], v37 offset:32768
    ds_read_b64_tr_b16 v[174:175], v38 offset:32768
    ds_read_b128 v[204:207], v45 offset:8192
    ds_read_b64_tr_b16 v[176:177], v37 offset:33792
    ds_read_b64_tr_b16 v[178:179], v38 offset:33792
    ds_read_b128 v[208:211], v46 offset:8192
    ds_read_b64_tr_b16 v[180:181], v37 offset:34816
    ds_read_b64_tr_b16 v[182:183], v38 offset:34816
    ds_read_b128 v[212:215], v47 offset:8192
    ds_read_b64_tr_b16 v[184:185], v37 offset:35840
    ds_read_b64_tr_b16 v[186:187], v38 offset:35840
    ds_read_b128 v[216:219], v48 offset:8192
    s_add_u32 m0, s89, 24576
    s_movk_i32 s82, 384
    buffer_load_dwordx4 v26, s[56:59], s82 offen offset:0 lds
    buffer_load_dwordx4 v27, s[56:59], s82 offen offset:1024 lds
    s_waitcnt lgkmcnt(9)
    v_mfma_f32_32x32x16_bf16 v[76:91], v[172:175], v[204:207], 0
    ds_read_b64_tr_b16 v[188:189], v39 offset:24576
    ds_read_b64_tr_b16 v[190:191], v40 offset:24576
    ds_read_b128 v[220:223], v49 offset:0
    s_waitcnt lgkmcnt(9)
    v_mfma_f32_32x32x16_bf16 v[76:91], v[176:179], v[208:211], v[76:91]
    ds_read_b64_tr_b16 v[192:193], v39 offset:25600
    ds_read_b64_tr_b16 v[194:195], v40 offset:25600
    ds_read_b128 v[224:227], v50 offset:0
    s_add_u32 m0, s89, 57344
    s_add_u32 s82, s88, 32768
    buffer_load_dwordx4 v5, s[64:67], s82 offen offset:0 sc1 lds
    buffer_load_dwordx4 v5, s[64:67], s82 offen offset:1024 sc1 lds
    s_waitcnt lgkmcnt(9)
    v_mfma_f32_32x32x16_bf16 v[76:91], v[180:183], v[212:215], v[76:91]
    ds_read_b64_tr_b16 v[196:197], v39 offset:26624
    ds_read_b64_tr_b16 v[198:199], v40 offset:26624
    ds_read_b128 v[228:231], v51 offset:0
    s_waitcnt lgkmcnt(9)
    v_mfma_f32_32x32x16_bf16 v[76:91], v[184:187], v[216:219], v[76:91]
    ds_read_b64_tr_b16 v[200:201], v39 offset:27648
    ds_read_b64_tr_b16 v[202:203], v40 offset:27648
    ds_read_b128 v[232:235], v52 offset:0
    s_add_u32 m0, s89, 32768
    s_movk_i32 s82, 512
    buffer_load_dwordx4 v26, s[52:55], s82 offen offset:0 lds
    buffer_load_dwordx4 v27, s[52:55], s82 offen offset:1024 lds
    s_waitcnt vmcnt(18)
    s_waitcnt vmcnt(16)
    s_barrier
    s_waitcnt lgkmcnt(9)
    v_mfma_f32_32x32x16_bf16 v[76:91], v[188:191], v[220:223], v[76:91]
    ds_read_b64_tr_b16 v[172:173], v39 offset:32768
    v_mul_f32 v140, v60, v156
    ds_read_b64_tr_b16 v[174:175], v40 offset:32768
    v_mul_f32 v141, v61, v157
    ds_read_b128 v[204:207], v45 offset:16384
    v_cvt_pk_bf16_f32 v142, v140, v141
    s_waitcnt lgkmcnt(9)
    v_mfma_f32_32x32x16_bf16 v[76:91], v[192:195], v[224:227], v[76:91]
    ds_read_b64_tr_b16 v[176:177], v39 offset:33792
    v_lshlrev_b32 v140, 16, v142
    ds_read_b64_tr_b16 v[178:179], v40 offset:33792
    v_and_b32 v141, 0xffff0000, v142
    ds_read_b128 v[208:211], v46 offset:16384
    s_add_u32 m0, s89, 106496
    s_add_u32 s82, s88, 34816
    buffer_load_dwordx4 v5, s[64:67], s82 offen offset:0 sc1 lds
    buffer_load_dwordx4 v5, s[64:67], s82 offen offset:1024 sc1 lds
    v_mul_f32 v142, s85, v140
    s_waitcnt lgkmcnt(9)
    v_mfma_f32_32x32x16_bf16 v[76:91], v[196:199], v[228:231], v[76:91]
    ds_read_b64_tr_b16 v[180:181], v39 offset:34816
    v_mul_f32 v143, s85, v141
    ds_read_b64_tr_b16 v[182:183], v40 offset:34816
    v_exp_f32 v142, -v142
    ds_read_b128 v[212:215], v47 offset:16384
    v_exp_f32 v143, -v143
    s_waitcnt lgkmcnt(9)
    v_mfma_f32_32x32x16_bf16 v[76:91], v[200:203], v[232:235], v[76:91]
    ds_read_b64_tr_b16 v[184:185], v39 offset:35840
    v_add_f32 v142, 1.0, v142
    ds_read_b64_tr_b16 v[186:187], v40 offset:35840
    v_add_f32 v143, 1.0, v143
    ds_read_b128 v[216:219], v48 offset:16384
    s_add_u32 m0, s89, 40960
    s_movk_i32 s82, 512
    buffer_load_dwordx4 v26, s[56:59], s82 offen offset:0 lds
    buffer_load_dwordx4 v27, s[56:59], s82 offen offset:1024 lds
    s_waitcnt lgkmcnt(9)
    v_mfma_f32_32x32x16_bf16 v[76:91], v[172:175], v[204:207], v[76:91]
    ds_read_b64_tr_b16 v[188:189], v35 offset:0
    v_rcp_f32 v142, v142
    ds_read_b64_tr_b16 v[190:191], v36 offset:0
    v_rcp_f32 v143, v143
    ds_read_b128 v[220:223], v49 offset:8192
    v_mul_f32 v140, v140, v142
    s_waitcnt lgkmcnt(9)
    v_mfma_f32_32x32x16_bf16 v[76:91], v[176:179], v[208:211], v[76:91]
    ds_read_b64_tr_b16 v[192:193], v35 offset:1024
    v_mul_f32 v141, v141, v143
    ds_read_b64_tr_b16 v[194:195], v36 offset:1024
    v_cvt_pk_bf16_f32 v142, v140, v141
    ds_read_b128 v[224:227], v50 offset:8192
    s_add_u32 m0, s89, 90112
    s_add_u32 s82, s88, 40960
    buffer_load_dwordx4 v5, s[64:67], s82 offen offset:0 sc1 lds
    buffer_load_dwordx4 v5, s[64:67], s82 offen offset:1024 sc1 lds
    v_lshlrev_b32 v124, 16, v142
    s_waitcnt lgkmcnt(9)
    v_mfma_f32_32x32x16_bf16 v[76:91], v[180:183], v[212:215], v[76:91]
    ds_read_b64_tr_b16 v[196:197], v35 offset:2048
    v_and_b32 v125, 0xffff0000, v142
    ds_read_b64_tr_b16 v[198:199], v36 offset:2048
    v_mul_f32 v144, v62, v158
    ds_read_b128 v[228:231], v51 offset:8192
    v_mul_f32 v145, v63, v159
    s_waitcnt lgkmcnt(9)
    v_mfma_f32_32x32x16_bf16 v[76:91], v[184:187], v[216:219], v[76:91]
    ds_read_b64_tr_b16 v[200:201], v35 offset:3072
    v_cvt_pk_bf16_f32 v146, v144, v145
    ds_read_b64_tr_b16 v[202:203], v36 offset:3072
    v_lshlrev_b32 v144, 16, v146
    ds_read_b128 v[232:235], v52 offset:8192
    s_add_u32 m0, s89, 65536
    s_movk_i32 s82, 640
    buffer_load_dwordx4 v26, s[52:55], s82 offen offset:0 lds
    buffer_load_dwordx4 v27, s[52:55], s82 offen offset:1024 lds
    s_waitcnt vmcnt(22)
    s_waitcnt vmcnt(20)
    s_barrier
    s_waitcnt lgkmcnt(9)
    v_mfma_f32_32x32x16_bf16 v[76:91], v[188:191], v[220:223], v[76:91]
    ds_read_b64_tr_b16 v[172:173], v39 offset:40960
    v_and_b32 v145, 0xffff0000, v146
    ds_read_b64_tr_b16 v[174:175], v40 offset:40960
    v_mul_f32 v146, s85, v144
    ds_read_b128 v[204:207], v45 offset:24576
    v_mul_f32 v147, s85, v145
    s_waitcnt lgkmcnt(9)
    v_mfma_f32_32x32x16_bf16 v[76:91], v[192:195], v[224:227], v[76:91]
    ds_read_b64_tr_b16 v[176:177], v39 offset:41984
    v_exp_f32 v146, -v146
    ds_read_b64_tr_b16 v[178:179], v40 offset:41984
    v_exp_f32 v147, -v147
    ds_read_b128 v[208:211], v46 offset:24576
    s_add_u32 m0, s89, 139264
    s_add_u32 s82, s88, 43008
    buffer_load_dwordx4 v5, s[64:67], s82 offen offset:0 sc1 lds
    buffer_load_dwordx4 v5, s[64:67], s82 offen offset:1024 sc1 lds
    v_add_f32 v146, 1.0, v146
    s_waitcnt lgkmcnt(9)
    v_mfma_f32_32x32x16_bf16 v[76:91], v[196:199], v[228:231], v[76:91]
    ds_read_b64_tr_b16 v[180:181], v39 offset:43008
    v_add_f32 v147, 1.0, v147
    ds_read_b64_tr_b16 v[182:183], v40 offset:43008
    v_rcp_f32 v146, v146
    ds_read_b128 v[212:215], v47 offset:24576
    v_rcp_f32 v147, v147
    s_waitcnt lgkmcnt(9)
    v_mfma_f32_32x32x16_bf16 v[76:91], v[200:203], v[232:235], v[76:91]
    ds_read_b64_tr_b16 v[184:185], v39 offset:44032
    v_mul_f32 v144, v144, v146
    ds_read_b64_tr_b16 v[186:187], v40 offset:44032
    v_mul_f32 v145, v145, v147
    ds_read_b128 v[216:219], v48 offset:24576
    s_add_u32 m0, s89, 114688
    s_movk_i32 s82, 640
    buffer_load_dwordx4 v26, s[56:59], s82 offen offset:0 lds
    buffer_load_dwordx4 v27, s[56:59], s82 offen offset:1024 lds
    s_waitcnt lgkmcnt(9)
    v_mfma_f32_32x32x16_bf16 v[76:91], v[172:175], v[204:207], v[76:91]
    ds_read_b64_tr_b16 v[188:189], v35 offset:8192
    v_cvt_pk_bf16_f32 v146, v144, v145
    ds_read_b64_tr_b16 v[190:191], v36 offset:8192
    v_lshlrev_b32 v126, 16, v146
    ds_read_b128 v[220:223], v49 offset:16384
    v_and_b32 v127, 0xffff0000, v146
    s_waitcnt lgkmcnt(9)
    v_mfma_f32_32x32x16_bf16 v[76:91], v[176:179], v[208:211], v[76:91]
    ds_read_b64_tr_b16 v[192:193], v35 offset:9216
    v_mul_f32 v148, v64, v160
    ds_read_b64_tr_b16 v[194:195], v36 offset:9216
    v_mul_f32 v149, v65, v161
    ds_read_b128 v[224:227], v50 offset:16384
    s_add_u32 m0, s89, 147456
    s_add_u32 s82, s88, 49152
    buffer_load_dwordx4 v5, s[64:67], s82 offen offset:0 sc1 lds
    buffer_load_dwordx4 v5, s[64:67], s82 offen offset:1024 sc1 lds
    v_cvt_pk_bf16_f32 v150, v148, v149
    s_waitcnt lgkmcnt(9)
    v_mfma_f32_32x32x16_bf16 v[76:91], v[180:183], v[212:215], v[76:91]
    ds_read_b64_tr_b16 v[196:197], v35 offset:10240
    v_lshlrev_b32 v148, 16, v150
    ds_read_b64_tr_b16 v[198:199], v36 offset:10240
    v_and_b32 v149, 0xffff0000, v150
    ds_read_b128 v[228:231], v51 offset:16384
    v_mul_f32 v150, s85, v148
    s_waitcnt lgkmcnt(9)
    v_mfma_f32_32x32x16_bf16 v[76:91], v[184:187], v[216:219], v[76:91]
    ds_read_b64_tr_b16 v[200:201], v35 offset:11264
    v_mul_f32 v151, s85, v149
    ds_read_b64_tr_b16 v[202:203], v36 offset:11264
    v_exp_f32 v150, -v150
    ds_read_b128 v[232:235], v52 offset:16384
    s_add_u32 m0, s89, 73728
    s_movk_i32 s82, 768
    buffer_load_dwordx4 v26, s[52:55], s82 offen offset:0 lds
    buffer_load_dwordx4 v27, s[52:55], s82 offen offset:1024 lds
    s_waitcnt vmcnt(26)
    s_waitcnt vmcnt(24)
    s_waitcnt vmcnt(22)
    s_waitcnt vmcnt(20)
    s_barrier
    s_waitcnt lgkmcnt(9)
    v_mfma_f32_32x32x16_bf16 v[76:91], v[188:191], v[220:223], v[76:91]
    ds_read_b64_tr_b16 v[172:173], v35 offset:49152
    v_exp_f32 v151, -v151
    ds_read_b64_tr_b16 v[174:175], v36 offset:49152
    v_add_f32 v150, 1.0, v150
    ds_read_b128 v[204:207], v41 offset:16384
    v_add_f32 v151, 1.0, v151
    s_waitcnt lgkmcnt(9)
    v_mfma_f32_32x32x16_bf16 v[76:91], v[192:195], v[224:227], v[76:91]
    ds_read_b64_tr_b16 v[176:177], v35 offset:50176
    v_rcp_f32 v150, v150
    ds_read_b64_tr_b16 v[178:179], v36 offset:50176
    v_rcp_f32 v151, v151
    ds_read_b128 v[208:211], v42 offset:16384
    s_add_u32 m0, s89, 0
    s_add_u32 s82, s88, 51200
    buffer_load_dwordx4 v5, s[64:67], s82 offen offset:0 sc1 lds
    buffer_load_dwordx4 v5, s[64:67], s82 offen offset:1024 sc1 lds
    v_mul_f32 v148, v148, v150
    s_waitcnt lgkmcnt(9)
    v_mfma_f32_32x32x16_bf16 v[76:91], v[196:199], v[228:231], v[76:91]
    ds_read_b64_tr_b16 v[180:181], v35 offset:51200
    v_mul_f32 v149, v149, v151
    ds_read_b64_tr_b16 v[182:183], v36 offset:51200
    v_cvt_pk_bf16_f32 v150, v148, v149
    ds_read_b128 v[212:215], v43 offset:16384
    v_lshlrev_b32 v128, 16, v150
    s_waitcnt lgkmcnt(9)
    v_mfma_f32_32x32x16_bf16 v[76:91], v[200:203], v[232:235], v[76:91]
    ds_read_b64_tr_b16 v[184:185], v35 offset:52224
    v_and_b32 v129, 0xffff0000, v150
    ds_read_b64_tr_b16 v[186:187], v36 offset:52224
    v_mul_f32 v152, v66, v162
    ds_read_b128 v[216:219], v44 offset:16384
    s_add_u32 m0, s89, 122880
    s_movk_i32 s82, 768
    buffer_load_dwordx4 v26, s[56:59], s82 offen offset:0 lds
    buffer_load_dwordx4 v27, s[56:59], s82 offen offset:1024 lds
    s_waitcnt lgkmcnt(9)
    v_mfma_f32_32x32x16_bf16 v[76:91], v[172:175], v[204:207], v[76:91]
    ds_read_b64_tr_b16 v[188:189], v37 offset:40960
    v_mul_f32 v153, v67, v163
    ds_read_b64_tr_b16 v[190:191], v38 offset:40960
    v_cvt_pk_bf16_f32 v154, v152, v153
    ds_read_b128 v[220:223], v41 offset:24576
    v_lshlrev_b32 v152, 16, v154
    s_waitcnt lgkmcnt(9)
    v_mfma_f32_32x32x16_bf16 v[76:91], v[176:179], v[208:211], v[76:91]
    ds_read_b64_tr_b16 v[192:193], v37 offset:41984
    v_and_b32 v153, 0xffff0000, v154
    ds_read_b64_tr_b16 v[194:195], v38 offset:41984
    v_mul_f32 v154, s85, v152
    ds_read_b128 v[224:227], v42 offset:24576
    s_add_u32 m0, s89, 155648
    s_add_u32 s82, s88, 57344
    buffer_load_dwordx4 v5, s[64:67], s82 offen offset:0 sc1 lds
    buffer_load_dwordx4 v5, s[64:67], s82 offen offset:1024 sc1 lds
    v_mul_f32 v155, s85, v153
    s_waitcnt lgkmcnt(9)
    v_mfma_f32_32x32x16_bf16 v[76:91], v[180:183], v[212:215], v[76:91]
    ds_read_b64_tr_b16 v[196:197], v37 offset:43008
    v_exp_f32 v154, -v154
    ds_read_b64_tr_b16 v[198:199], v38 offset:43008
    v_exp_f32 v155, -v155
    ds_read_b128 v[228:231], v43 offset:24576
    v_add_f32 v154, 1.0, v154
    s_waitcnt lgkmcnt(9)
    v_mfma_f32_32x32x16_bf16 v[76:91], v[184:187], v[216:219], v[76:91]
    ds_read_b64_tr_b16 v[200:201], v37 offset:44032
    v_add_f32 v155, 1.0, v155
    ds_read_b64_tr_b16 v[202:203], v38 offset:44032
    v_rcp_f32 v154, v154
    ds_read_b128 v[232:235], v44 offset:24576
    s_add_u32 m0, s89, 81920
    s_movk_i32 s82, 896
    buffer_load_dwordx4 v26, s[52:55], s82 offen offset:0 lds
    buffer_load_dwordx4 v27, s[52:55], s82 offen offset:1024 lds
    s_waitcnt vmcnt(26)
    s_waitcnt vmcnt(24)
    s_waitcnt vmcnt(22)
    s_waitcnt vmcnt(20)
    s_barrier
    s_waitcnt lgkmcnt(9)
    v_mfma_f32_32x32x16_bf16 v[76:91], v[188:191], v[220:223], v[76:91]
    ds_read_b64_tr_b16 v[172:173], v37 offset:0
    v_rcp_f32 v155, v155
    ds_read_b64_tr_b16 v[174:175], v38 offset:0
    v_mul_f32 v152, v152, v154
    ds_read_b128 v[204:207], v41 offset:32768
    v_mul_f32 v153, v153, v155
    s_waitcnt lgkmcnt(9)
    v_mfma_f32_32x32x16_bf16 v[76:91], v[192:195], v[224:227], v[76:91]
    ds_read_b64_tr_b16 v[176:177], v37 offset:1024
    v_cvt_pk_bf16_f32 v154, v152, v153
    ds_read_b64_tr_b16 v[178:179], v38 offset:1024
    v_lshlrev_b32 v130, 16, v154
    ds_read_b128 v[208:211], v42 offset:32768
    v_and_b32 v131, 0xffff0000, v154
    s_waitcnt lgkmcnt(9)
    v_mfma_f32_32x32x16_bf16 v[76:91], v[196:199], v[228:231], v[76:91]
    ds_read_b64_tr_b16 v[180:181], v37 offset:2048
    v_mul_f32 v140, v68, v164
    ds_read_b64_tr_b16 v[182:183], v38 offset:2048
    v_mul_f32 v141, v69, v165
    ds_read_b128 v[212:215], v43 offset:32768
    v_cvt_pk_bf16_f32 v142, v140, v141
    s_waitcnt lgkmcnt(9)
    v_mfma_f32_32x32x16_bf16 v[76:91], v[200:203], v[232:235], v[76:91]
    ds_read_b64_tr_b16 v[184:185], v37 offset:3072
    v_lshlrev_b32 v140, 16, v142
    ds_read_b64_tr_b16 v[186:187], v38 offset:3072
    v_and_b32 v141, 0xffff0000, v142
    ds_read_b128 v[216:219], v44 offset:32768
    s_add_u32 m0, s89, 8192
    s_add_u32 s82, s88, 59392
    buffer_load_dwordx4 v5, s[64:67], s82 offen offset:0 sc1 lds
    buffer_load_dwordx4 v5, s[64:67], s82 offen offset:1024 sc1 lds
    s_waitcnt lgkmcnt(9)
    v_mfma_f32_32x32x16_bf16 v[76:91], v[172:175], v[204:207], v[76:91]
    ds_read_b64_tr_b16 v[188:189], v37 offset:49152
    v_mul_f32 v142, s85, v140
    ds_read_b64_tr_b16 v[190:191], v38 offset:49152
    v_mul_f32 v143, s85, v141
    ds_read_b128 v[220:223], v41 offset:40960
    v_exp_f32 v142, -v142
    s_waitcnt lgkmcnt(9)
    v_mfma_f32_32x32x16_bf16 v[76:91], v[176:179], v[208:211], v[76:91]
    ds_read_b64_tr_b16 v[192:193], v37 offset:50176
    v_exp_f32 v143, -v143
    ds_read_b64_tr_b16 v[194:195], v38 offset:50176
    v_add_f32 v142, 1.0, v142
    ds_read_b128 v[224:227], v42 offset:40960
    v_add_f32 v143, 1.0, v143
    s_waitcnt lgkmcnt(9)
    v_mfma_f32_32x32x16_bf16 v[76:91], v[180:183], v[212:215], v[76:91]
    ds_read_b64_tr_b16 v[196:197], v37 offset:51200
    v_rcp_f32 v142, v142
    ds_read_b64_tr_b16 v[198:199], v38 offset:51200
    v_rcp_f32 v143, v143
    ds_read_b128 v[228:231], v43 offset:40960
    v_mul_f32 v140, v140, v142
    s_waitcnt lgkmcnt(9)
    v_mfma_f32_32x32x16_bf16 v[76:91], v[184:187], v[216:219], v[76:91]
    ds_read_b64_tr_b16 v[200:201], v37 offset:52224
    v_mul_f32 v141, v141, v143
    ds_read_b64_tr_b16 v[202:203], v38 offset:52224
    v_cvt_pk_bf16_f32 v142, v140, v141
    ds_read_b128 v[232:235], v44 offset:40960
    s_add_u32 m0, s89, 131072
    s_movk_i32 s82, 896
    buffer_load_dwordx4 v26, s[56:59], s82 offen offset:0 lds
    buffer_load_dwordx4 v27, s[56:59], s82 offen offset:1024 lds
    s_waitcnt vmcnt(22)
    s_waitcnt vmcnt(20)
    s_waitcnt vmcnt(18)
    s_waitcnt vmcnt(16)
    s_barrier
    s_waitcnt lgkmcnt(9)
    v_mfma_f32_32x32x16_bf16 v[76:91], v[188:191], v[220:223], v[76:91]
    ds_read_b64_tr_b16 v[172:173], v37 offset:32768
    v_lshlrev_b32 v132, 16, v142
    ds_read_b64_tr_b16 v[174:175], v38 offset:32768
    v_and_b32 v133, 0xffff0000, v142
    ds_read_b128 v[204:207], v45 offset:8192
    v_mul_f32 v144, v70, v166
    s_waitcnt lgkmcnt(9)
    v_mfma_f32_32x32x16_bf16 v[76:91], v[192:195], v[224:227], v[76:91]
    ds_read_b64_tr_b16 v[176:177], v37 offset:33792
    v_mul_f32 v145, v71, v167
    ds_read_b64_tr_b16 v[178:179], v38 offset:33792
    v_cvt_pk_bf16_f32 v146, v144, v145
    ds_read_b128 v[208:211], v46 offset:8192
    v_lshlrev_b32 v144, 16, v146
    s_waitcnt lgkmcnt(9)
    v_mfma_f32_32x32x16_bf16 v[76:91], v[196:199], v[228:231], v[76:91]
    ds_read_b64_tr_b16 v[180:181], v37 offset:34816
    v_and_b32 v145, 0xffff0000, v146
    ds_read_b64_tr_b16 v[182:183], v38 offset:34816
    v_mul_f32 v146, s85, v144
    ds_read_b128 v[212:215], v47 offset:8192
    v_mul_f32 v147, s85, v145
    s_waitcnt lgkmcnt(9)
    v_mfma_f32_32x32x16_bf16 v[76:91], v[200:203], v[232:235], v[76:91]
    ds_read_b64_tr_b16 v[184:185], v37 offset:35840
    v_exp_f32 v146, -v146
    ds_read_b64_tr_b16 v[186:187], v38 offset:35840
    v_exp_f32 v147, -v147
    ds_read_b128 v[216:219], v48 offset:8192
    s_waitcnt lgkmcnt(9)
    v_mfma_f32_32x32x16_bf16 v[76:91], v[172:175], v[204:207], v[76:91]
    ds_read_b64_tr_b16 v[188:189], v39 offset:24576
    v_add_f32 v146, 1.0, v146
    ds_read_b64_tr_b16 v[190:191], v40 offset:24576
    v_add_f32 v147, 1.0, v147
    ds_read_b128 v[220:223], v49 offset:0
    v_rcp_f32 v146, v146
    s_waitcnt lgkmcnt(9)
    v_mfma_f32_32x32x16_bf16 v[76:91], v[176:179], v[208:211], v[76:91]
    ds_read_b64_tr_b16 v[192:193], v39 offset:25600
    v_rcp_f32 v147, v147
    ds_read_b64_tr_b16 v[194:195], v40 offset:25600
    v_mul_f32 v144, v144, v146
    ds_read_b128 v[224:227], v50 offset:0
    v_mul_f32 v145, v145, v147
    s_waitcnt lgkmcnt(9)
    v_mfma_f32_32x32x16_bf16 v[76:91], v[180:183], v[212:215], v[76:91]
    ds_read_b64_tr_b16 v[196:197], v39 offset:26624
    v_cvt_pk_bf16_f32 v146, v144, v145
    ds_read_b64_tr_b16 v[198:199], v40 offset:26624
    v_lshlrev_b32 v134, 16, v146
    ds_read_b128 v[228:231], v51 offset:0
    v_and_b32 v135, 0xffff0000, v146
    s_waitcnt lgkmcnt(9)
    v_mfma_f32_32x32x16_bf16 v[76:91], v[184:187], v[216:219], v[76:91]
    ds_read_b64_tr_b16 v[200:201], v39 offset:27648
    v_mul_f32 v148, v72, v168
    ds_read_b64_tr_b16 v[202:203], v40 offset:27648
    v_mul_f32 v149, v73, v169
    ds_read_b128 v[232:235], v52 offset:0
    s_waitcnt vmcnt(14)
    s_waitcnt vmcnt(12)
    s_waitcnt vmcnt(10)
    s_waitcnt vmcnt(8)
    s_barrier
    s_waitcnt lgkmcnt(9)
    v_mfma_f32_32x32x16_bf16 v[76:91], v[188:191], v[220:223], v[76:91]
    ds_read_b64_tr_b16 v[172:173], v39 offset:32768
    v_cvt_pk_bf16_f32 v150, v148, v149
    ds_read_b64_tr_b16 v[174:175], v40 offset:32768
    v_lshlrev_b32 v148, 16, v150
    ds_read_b128 v[204:207], v45 offset:16384
    v_and_b32 v149, 0xffff0000, v150
    s_waitcnt lgkmcnt(9)
    v_mfma_f32_32x32x16_bf16 v[76:91], v[192:195], v[224:227], v[76:91]
    ds_read_b64_tr_b16 v[176:177], v39 offset:33792
    v_mul_f32 v150, s85, v148
    ds_read_b64_tr_b16 v[178:179], v40 offset:33792
    v_mul_f32 v151, s85, v149
    ds_read_b128 v[208:211], v46 offset:16384
    v_exp_f32 v150, -v150
    s_waitcnt lgkmcnt(9)
    v_mfma_f32_32x32x16_bf16 v[76:91], v[196:199], v[228:231], v[76:91]
    ds_read_b64_tr_b16 v[180:181], v39 offset:34816
    v_exp_f32 v151, -v151
    ds_read_b64_tr_b16 v[182:183], v40 offset:34816
    v_add_f32 v150, 1.0, v150
    ds_read_b128 v[212:215], v47 offset:16384
    v_add_f32 v151, 1.0, v151
    s_waitcnt lgkmcnt(9)
    v_mfma_f32_32x32x16_bf16 v[76:91], v[200:203], v[232:235], v[76:91]
    ds_read_b64_tr_b16 v[184:185], v39 offset:35840
    v_rcp_f32 v150, v150
    ds_read_b64_tr_b16 v[186:187], v40 offset:35840
    v_rcp_f32 v151, v151
    ds_read_b128 v[216:219], v48 offset:16384
    s_waitcnt lgkmcnt(9)
    v_mfma_f32_32x32x16_bf16 v[76:91], v[172:175], v[204:207], v[76:91]
    ds_read_b64_tr_b16 v[188:189], v35 offset:0
    v_mul_f32 v148, v148, v150
    ds_read_b64_tr_b16 v[190:191], v36 offset:0
    v_mul_f32 v149, v149, v151
    ds_read_b128 v[220:223], v49 offset:8192
    v_cvt_pk_bf16_f32 v150, v148, v149
    s_waitcnt lgkmcnt(9)
    v_mfma_f32_32x32x16_bf16 v[76:91], v[176:179], v[208:211], v[76:91]
    ds_read_b64_tr_b16 v[192:193], v35 offset:1024
    v_lshlrev_b32 v136, 16, v150
    ds_read_b64_tr_b16 v[194:195], v36 offset:1024
    v_and_b32 v137, 0xffff0000, v150
    ds_read_b128 v[224:227], v50 offset:8192
    v_mul_f32 v152, v74, v170
    s_waitcnt lgkmcnt(9)
    v_mfma_f32_32x32x16_bf16 v[76:91], v[180:183], v[212:215], v[76:91]
    ds_read_b64_tr_b16 v[196:197], v35 offset:2048
    v_mul_f32 v153, v75, v171
    ds_read_b64_tr_b16 v[198:199], v36 offset:2048
    v_cvt_pk_bf16_f32 v154, v152, v153
    ds_read_b128 v[228:231], v51 offset:8192
    v_lshlrev_b32 v152, 16, v154
    s_waitcnt lgkmcnt(9)
    v_mfma_f32_32x32x16_bf16 v[76:91], v[184:187], v[216:219], v[76:91]
    ds_read_b64_tr_b16 v[200:201], v35 offset:3072
    v_and_b32 v153, 0xffff0000, v154
    ds_read_b64_tr_b16 v[202:203], v36 offset:3072
    v_mul_f32 v154, s85, v152
    ds_read_b128 v[232:235], v52 offset:8192
    s_waitcnt vmcnt(6)
    s_waitcnt vmcnt(4)
    s_waitcnt vmcnt(2)
    s_waitcnt vmcnt(0)
    s_barrier
    s_waitcnt lgkmcnt(9)
    v_mfma_f32_32x32x16_bf16 v[76:91], v[188:191], v[220:223], v[76:91]
    ds_read_b64_tr_b16 v[172:173], v39 offset:40960
    v_mul_f32 v155, s85, v153
    ds_read_b64_tr_b16 v[174:175], v40 offset:40960
    v_exp_f32 v154, -v154
    ds_read_b128 v[204:207], v45 offset:24576
    v_exp_f32 v155, -v155
    s_waitcnt lgkmcnt(9)
    v_mfma_f32_32x32x16_bf16 v[76:91], v[192:195], v[224:227], v[76:91]
    ds_read_b64_tr_b16 v[176:177], v39 offset:41984
    v_add_f32 v154, 1.0, v154
    ds_read_b64_tr_b16 v[178:179], v40 offset:41984
    v_add_f32 v155, 1.0, v155
    ds_read_b128 v[208:211], v46 offset:24576
    v_rcp_f32 v154, v154
    s_waitcnt lgkmcnt(9)
    v_mfma_f32_32x32x16_bf16 v[76:91], v[196:199], v[228:231], v[76:91]
    ds_read_b64_tr_b16 v[180:181], v39 offset:43008
    v_rcp_f32 v155, v155
    ds_read_b64_tr_b16 v[182:183], v40 offset:43008
    v_mul_f32 v152, v152, v154
    ds_read_b128 v[212:215], v47 offset:24576
    v_mul_f32 v153, v153, v155
    s_waitcnt lgkmcnt(9)
    v_mfma_f32_32x32x16_bf16 v[76:91], v[200:203], v[232:235], v[76:91]
    ds_read_b64_tr_b16 v[184:185], v39 offset:44032
    v_cvt_pk_bf16_f32 v154, v152, v153
    ds_read_b64_tr_b16 v[186:187], v40 offset:44032
    v_lshlrev_b32 v138, 16, v154
    ds_read_b128 v[216:219], v48 offset:24576
    s_waitcnt lgkmcnt(9)
    v_mfma_f32_32x32x16_bf16 v[76:91], v[172:175], v[204:207], v[76:91]
    ds_read_b64_tr_b16 v[188:189], v35 offset:8192
    v_and_b32 v139, 0xffff0000, v154
    ds_read_b64_tr_b16 v[190:191], v36 offset:8192
    ds_read_b128 v[220:223], v49 offset:16384
    s_waitcnt lgkmcnt(9)
    v_mfma_f32_32x32x16_bf16 v[76:91], v[176:179], v[208:211], v[76:91]
    ds_read_b64_tr_b16 v[192:193], v35 offset:9216
    ds_read_b64_tr_b16 v[194:195], v36 offset:9216
    ds_read_b128 v[224:227], v50 offset:16384
    s_waitcnt lgkmcnt(9)
    v_mfma_f32_32x32x16_bf16 v[76:91], v[180:183], v[212:215], v[76:91]
    ds_read_b64_tr_b16 v[196:197], v35 offset:10240
    ds_read_b64_tr_b16 v[198:199], v36 offset:10240
    ds_read_b128 v[228:231], v51 offset:16384
    s_waitcnt lgkmcnt(9)
    v_mfma_f32_32x32x16_bf16 v[76:91], v[184:187], v[216:219], v[76:91]
    ds_read_b64_tr_b16 v[200:201], v35 offset:11264
    ds_read_b64_tr_b16 v[202:203], v36 offset:11264
    ds_read_b128 v[232:235], v52 offset:16384
    s_waitcnt lgkmcnt(9)
    v_mfma_f32_32x32x16_bf16 v[76:91], v[188:191], v[220:223], v[76:91]
    s_waitcnt lgkmcnt(6)
    v_mfma_f32_32x32x16_bf16 v[76:91], v[192:195], v[224:227], v[76:91]
    s_waitcnt lgkmcnt(3)
    v_mfma_f32_32x32x16_bf16 v[76:91], v[196:199], v[228:231], v[76:91]
    s_waitcnt lgkmcnt(0)
    v_mfma_f32_32x32x16_bf16 v[76:91], v[200:203], v[232:235], v[76:91]
    s_nop 11
    v_add_f32 v108, v76, v108
    v_fma_f32 v92, v108, v124, v92
    buffer_store_dword v92, v53, s[60:63], s8 offen offset:0 sc0 sc1
    v_add_f32 v109, v77, v109
    v_fma_f32 v93, v109, v125, v93
    buffer_store_dword v93, v53, s[60:63], s8 offen offset:2048 sc0 sc1
    v_add_f32 v110, v78, v110
    v_fma_f32 v94, v110, v126, v94
    buffer_store_dword v94, v53, s[60:63], s9 offen offset:0 sc0 sc1
    v_add_f32 v111, v79, v111
    v_fma_f32 v95, v111, v127, v95
    buffer_store_dword v95, v53, s[60:63], s9 offen offset:2048 sc0 sc1
    v_add_f32 v112, v80, v112
    v_fma_f32 v96, v112, v128, v96
    buffer_store_dword v96, v53, s[60:63], s10 offen offset:0 sc0 sc1
    v_add_f32 v113, v81, v113
    v_fma_f32 v97, v113, v129, v97
    buffer_store_dword v97, v53, s[60:63], s10 offen offset:2048 sc0 sc1
    v_add_f32 v114, v82, v114
    v_fma_f32 v98, v114, v130, v98
    buffer_store_dword v98, v53, s[60:63], s11 offen offset:0 sc0 sc1
    v_add_f32 v115, v83, v115
    v_fma_f32 v99, v115, v131, v99
    buffer_store_dword v99, v53, s[60:63], s11 offen offset:2048 sc0 sc1
    v_add_f32 v116, v84, v116
    v_fma_f32 v100, v116, v132, v100
    buffer_store_dword v100, v53, s[60:63], s12 offen offset:0 sc0 sc1
    v_add_f32 v117, v85, v117
    v_fma_f32 v101, v117, v133, v101
    buffer_store_dword v101, v53, s[60:63], s12 offen offset:2048 sc0 sc1
    v_add_f32 v118, v86, v118
    v_fma_f32 v102, v118, v134, v102
    buffer_store_dword v102, v53, s[60:63], s13 offen offset:0 sc0 sc1
    v_add_f32 v119, v87, v119
    v_fma_f32 v103, v119, v135, v103
    buffer_store_dword v103, v53, s[60:63], s13 offen offset:2048 sc0 sc1
    v_add_f32 v120, v88, v120
    v_fma_f32 v104, v120, v136, v104
    buffer_store_dword v104, v53, s[60:63], s14 offen offset:0 sc0 sc1
    v_add_f32 v121, v89, v121
    v_fma_f32 v105, v121, v137, v105
    buffer_store_dword v105, v53, s[60:63], s14 offen offset:2048 sc0 sc1
    v_add_f32 v122, v90, v122
    v_fma_f32 v106, v122, v138, v106
    buffer_store_dword v106, v53, s[60:63], s15 offen offset:0 sc0 sc1
    v_add_f32 v123, v91, v123
    v_fma_f32 v107, v123, v139, v107
    buffer_store_dword v107, v53, s[60:63], s15 offen offset:2048 sc0 sc1
    s_endpgm
L_comp:
    s_and_b32 s83, s72, 1
    s_lshr_b32 s84, s72, 1
    v_and_b32 v8, 1, v1
    v_lshlrev_b32 v8, 3, v8
    v_bfe_u32 v9, v1, 1, 1
    v_add_u32 v8, v8, v9
    v_bfe_u32 v9, v1, 3, 2
    v_lshl_add_u32 v8, v9, 1, v8
    v_bfe_u32 v9, v1, 2, 1
    v_lshl_add_u32 v8, v9, 5, v8
    s_lshl_b32 s79, s83, 6
    v_add_u32 v8, s79, v8
    v_lshlrev_b32 v10, 4, v8
    v_add_u32 v37, 147456, v10
    v_bfe_u32 v9, v8, 1, 3
    v_xor_b32 v9, v9, v2
    v_lshlrev_b32 v8, 7, v8
    v_xor_b32 v11, 0, v9
    v_lshl_add_u32 v28, v11, 4, v8
    v_xor_b32 v11, 2, v9
    v_lshl_add_u32 v29, v11, 4, v8
    v_xor_b32 v11, 4, v9
    v_lshl_add_u32 v30, v11, 4, v8
    v_xor_b32 v11, 6, v9
    v_lshl_add_u32 v31, v11, 4, v8
    v_and_b32 v8, 31, v1
    s_lshl_b32 s79, s84, 11
    s_add_u32 s79, s79, 149504
    v_lshl_add_u32 v38, v8, 4, s79
    v_bfe_u32 v9, v8, 1, 3
    v_xor_b32 v9, v9, v2
    v_lshlrev_b32 v8, 7, v8
    v_add_u32 v8, 16384, v8
    v_xor_b32 v11, 0, v9
    v_lshl_add_u32 v32, v11, 4, v8
    v_xor_b32 v11, 2, v9
    v_lshl_add_u32 v33, v11, 4, v8
    v_xor_b32 v11, 4, v9
    v_lshl_add_u32 v34, v11, 4, v8
    v_xor_b32 v11, 6, v9
    v_lshl_add_u32 v35, v11, 4, v8
    v_bfe_u32 v8, v1, 2, 2
    v_lshl_add_u32 v8, v2, 3, v8
    v_lshlrev_b32 v8, 6, v8
    v_bfe_u32 v9, v1, 4, 1
    v_lshl_add_u32 v8, v9, 5, v8
    v_and_b32 v9, 3, v1
    v_lshl_add_u32 v6, v9, 3, v8
    v_add_u32 v36, 24576, v6
    s_lshl_b32 s79, s83, 8
    s_add_u32 s79, s79, 153600
    v_lshl_add_u32 v39, v2, 7, s79
    v_and_b32 v8, 15, v1
    v_bfe_u32 v9, v1, 4, 1
    v_lshlrev_b32 v9, 10, v9
    v_mul_u32_u24 v10, 153600, v2
    v_add_u32 v9, v9, v10
    v_xor_b32 v11, 0, v8
    v_lshl_add_u32 v40, v11, 4, v9
    v_xor_b32 v11, 4, v8
    v_lshl_add_u32 v41, v11, 4, v9
    v_add_u32 v41, 256, v41
    v_xor_b32 v11, 8, v8
    v_lshl_add_u32 v42, v11, 4, v9
    v_add_u32 v42, 512, v42
    v_xor_b32 v11, 12, v8
    v_lshl_add_u32 v43, v11, 4, v9
    v_add_u32 v43, 768, v43
    s_lshl_b32 s93, s74, 1
    s_add_u32 s93, s93, s83
    s_mul_i32 s79, s93, 300
    s_lshl_b32 s80, s75, 2
    s_add_u32 s80, s80, 86
    s_add_u32 s87, s79, s80
    s_lshl_b32 s87, s87, 10
    s_mul_i32 s80, s75, 6
    s_cmp_eq_u32 s84, 0
    s_cselect_b32 s81, 0, 2
    s_add_u32 s81, s81, s80
    s_add_u32 s85, s79, s81
    s_lshl_b32 s85, s85, 10
    s_cmp_ge_u32 s81, 86
    s_cselect_b32 s85, 1073741824, s85
    s_cmp_eq_u32 s84, 0
    s_cselect_b32 s81, 0, 4
    s_add_u32 s81, s81, s80
    s_add_u32 s86, s79, s81
    s_lshl_b32 s86, s86, 10
    s_cmp_ge_u32 s81, 86
    s_cselect_b32 s86, 1073741824, s86
    s_lshl_b32 s92, s93, 4
    s_add_u32 s92, s92, s75
    v_and_b32 v12, 31, v1
    s_lshl_b32 s79, s75, 5
    v_add_lshl_u32 v12, v12, s79, 1
    s_waitcnt lgkmcnt(0)
    s_mov_b32 s64, s42
    s_mov_b32 s65, s43
    s_mov_b32 s66, 11403264
    s_mov_b32 s67, 0x20000
    s_cmp_eq_u32 s72, 3
    s_cbranch_scc0 L_npf
    s_getpc_b64 s[8:9]
L_pc:
    s_sub_u32 s8, s8, L_pc-recurrent_scan__ssm_conv_s5__glu_gated_reglu__prompt_kernel
    s_subb_u32 s9, s9, 0
    s_lshr_b32 s79, s2, 3
    s_lshl_b32 s79, s79, 11
    v_lshl_add_u32 v8, v1, 7, s79
    v_min_u32 v8, L_end-recurrent_scan__ssm_conv_s5__glu_gated_reglu__prompt_kernel, v8
    s_mov_b64 exec, 0xffff
    global_load_dword v55, v8, s[8:9]
    s_mov_b64 exec, -1
L_npf:
    s_or_b32 s79, s2, s72
    s_cmp_lg_u32 s79, 0
    s_cbranch_scc1 L_nn
    s_or_b32 s79, s98, 1
    v_mov_b32 v8, s79
    v_mov_b32 v9, s99
    s_mov_b64 exec, 1
    global_store_dwordx2 v4, v[8:9], s[40:41] sc0 sc1
    s_mov_b64 exec, -1
L_nn:
    s_cmp_eq_u32 s84, 0
    s_cbranch_scc0 L_c1
    global_load_ushort v52, v12, s[18:19]
    global_load_ushort v53, v12, s[20:21]
    global_load_ushort v54, v12, s[30:31]
    s_mov_b32 s88, 1069066811
    s_mov_b32 s89, 849703008
    s_mov_b32 s90, 1060205080
    s_mov_b32 s91, 1042479491
    s_barrier
    ds_read_b128 v[184:187], v28 offset:0
    ds_read_b128 v[200:203], v32
    ds_read_b128 v[188:191], v28 offset:2048
    ds_read_b128 v[204:207], v32 offset:4096
    ds_read_b64_tr_b16 v[208:209], v36 offset:0
    ds_read_b64_tr_b16 v[210:211], v36 offset:256
    ds_read_b64_tr_b16 v[212:213], v36 offset:12288
    ds_read_b64_tr_b16 v[214:215], v36 offset:12544
    s_waitcnt lgkmcnt(6)
    v_mfma_f32_32x32x16_bf16 v[56:71], v[184:187], v[200:203], 0
    ds_read_b128 v[192:195], v29 offset:0
    ds_read_b128 v[216:219], v33
    s_waitcnt lgkmcnt(7)
    v_mfma_f32_32x32x16_bf16 v[72:87], v[188:191], v[200:203], 0
    ds_read_b128 v[196:199], v29 offset:2048
    s_waitcnt lgkmcnt(7)
    v_mfma_f32_32x32x16_bf16 v[88:103], v[184:187], v[204:207], 0
    ds_read_b128 v[220:223], v33 offset:4096
    v_mfma_f32_32x32x16_bf16 v[104:119], v[188:191], v[204:207], 0
    ds_read_b64_tr_b16 v[224:225], v36 offset:3072
    ds_read_b64_tr_b16 v[226:227], v36 offset:3328
    s_waitcnt lgkmcnt(8)
    v_mfma_f32_32x32x16_bf16 v[120:135], v[184:187], v[208:211], 0
    ds_read_b64_tr_b16 v[228:229], v36 offset:15360
    v_mfma_f32_32x32x16_bf16 v[136:151], v[188:191], v[208:211], 0
    ds_read_b64_tr_b16 v[230:231], v36 offset:15616
    s_waitcnt lgkmcnt(8)
    v_mfma_f32_32x32x16_bf16 v[152:167], v[184:187], v[212:215], 0
    v_mfma_f32_32x32x16_bf16 v[168:183], v[188:191], v[212:215], 0
    s_waitcnt lgkmcnt(6)
    v_mfma_f32_32x32x16_bf16 v[56:71], v[192:195], v[216:219], v[56:71]
    ds_read_b128 v[184:187], v30 offset:0
    ds_read_b128 v[200:203], v34
    s_waitcnt lgkmcnt(7)
    v_mfma_f32_32x32x16_bf16 v[72:87], v[196:199], v[216:219], v[72:87]
    ds_read_b128 v[188:191], v30 offset:2048
    s_waitcnt lgkmcnt(7)
    v_mfma_f32_32x32x16_bf16 v[88:103], v[192:195], v[220:223], v[88:103]
    ds_read_b128 v[204:207], v34 offset:4096
    v_mfma_f32_32x32x16_bf16 v[104:119], v[196:199], v[220:223], v[104:119]
    ds_read_b64_tr_b16 v[208:209], v36 offset:6144
    ds_read_b64_tr_b16 v[210:211], v36 offset:6400
    s_waitcnt lgkmcnt(8)
    v_mfma_f32_32x32x16_bf16 v[120:135], v[192:195], v[224:227], v[120:135]
    ds_read_b64_tr_b16 v[212:213], v36 offset:18432
    v_mfma_f32_32x32x16_bf16 v[136:151], v[196:199], v[224:227], v[136:151]
    ds_read_b64_tr_b16 v[214:215], v36 offset:18688
    s_waitcnt lgkmcnt(8)
    v_mfma_f32_32x32x16_bf16 v[152:167], v[192:195], v[228:231], v[152:167]
    v_mfma_f32_32x32x16_bf16 v[168:183], v[196:199], v[228:231], v[168:183]
    s_waitcnt lgkmcnt(6)
    v_mfma_f32_32x32x16_bf16 v[56:71], v[184:187], v[200:203], v[56:71]
    ds_read_b128 v[192:195], v31 offset:0
    ds_read_b128 v[216:219], v35
    s_waitcnt lgkmcnt(7)
    v_mfma_f32_32x32x16_bf16 v[72:87], v[188:191], v[200:203], v[72:87]
    ds_read_b128 v[196:199], v31 offset:2048
    s_waitcnt lgkmcnt(7)
    v_mfma_f32_32x32x16_bf16 v[88:103], v[184:187], v[204:207], v[88:103]
    ds_read_b128 v[220:223], v35 offset:4096
    v_mfma_f32_32x32x16_bf16 v[104:119], v[188:191], v[204:207], v[104:119]
    ds_read_b64_tr_b16 v[224:225], v36 offset:9216
    ds_read_b64_tr_b16 v[226:227], v36 offset:9472
    s_waitcnt lgkmcnt(8)
    v_mfma_f32_32x32x16_bf16 v[120:135], v[184:187], v[208:211], v[120:135]
    ds_read_b64_tr_b16 v[228:229], v36 offset:21504
    v_mfma_f32_32x32x16_bf16 v[136:151], v[188:191], v[208:211], v[136:151]
    ds_read_b64_tr_b16 v[230:231], v36 offset:21760
    s_waitcnt lgkmcnt(8)
    v_mfma_f32_32x32x16_bf16 v[152:167], v[184:187], v[212:215], v[152:167]
    v_mfma_f32_32x32x16_bf16 v[168:183], v[188:191], v[212:215], v[168:183]
    s_waitcnt lgkmcnt(0)
    s_barrier
    v_mfma_f32_32x32x16_bf16 v[56:71], v[192:195], v[216:219], v[56:71]
    v_add_u32 v28, 49152, v28
    v_add_u32 v32, 49152, v32
    v_add_u32 v36, 49152, v36
    v_mfma_f32_32x32x16_bf16 v[72:87], v[196:199], v[216:219], v[72:87]
    ds_read_b128 v[184:187], v28 offset:0
    ds_read_b128 v[200:203], v32
    ds_read_b128 v[188:191], v28 offset:2048
    v_mfma_f32_32x32x16_bf16 v[88:103], v[192:195], v[220:223], v[88:103]
    ds_read_b128 v[204:207], v32 offset:4096
    ds_read_b64_tr_b16 v[208:209], v36 offset:0
    ds_read_b64_tr_b16 v[210:211], v36 offset:256
    v_mfma_f32_32x32x16_bf16 v[104:119], v[196:199], v[220:223], v[104:119]
    ds_read_b64_tr_b16 v[212:213], v36 offset:12288
    ds_read_b64_tr_b16 v[214:215], v36 offset:12544
    v_add_u32 v29, 49152, v29
    v_mfma_f32_32x32x16_bf16 v[120:135], v[192:195], v[224:227], v[120:135]
    v_add_u32 v30, 49152, v30
    v_add_u32 v31, 49152, v31
    v_add_u32 v33, 49152, v33
    v_mfma_f32_32x32x16_bf16 v[136:151], v[196:199], v[224:227], v[136:151]
    v_add_u32 v34, 49152, v34
    v_add_u32 v35, 49152, v35
    v_mfma_f32_32x32x16_bf16 v[152:167], v[192:195], v[228:231], v[152:167]
    v_mfma_f32_32x32x16_bf16 v[168:183], v[196:199], v[228:231], v[168:183]
    s_waitcnt lgkmcnt(6)
    v_mfma_f32_32x32x16_bf16 v[56:71], v[184:187], v[200:203], v[56:71]
    ds_read_b128 v[192:195], v29 offset:0
    ds_read_b128 v[216:219], v33
    ds_read_b128 v[196:199], v29 offset:2048
    s_waitcnt lgkmcnt(8)
    v_mfma_f32_32x32x16_bf16 v[72:87], v[188:191], v[200:203], v[72:87]
    ds_read_b128 v[220:223], v33 offset:4096
    ds_read_b64_tr_b16 v[224:225], v36 offset:3072
    s_waitcnt lgkmcnt(9)
    v_mfma_f32_32x32x16_bf16 v[88:103], v[184:187], v[204:207], v[88:103]
    ds_read_b64_tr_b16 v[226:227], v36 offset:3328
    ds_read_b64_tr_b16 v[228:229], v36 offset:15360
    v_mfma_f32_32x32x16_bf16 v[104:119], v[188:191], v[204:207], v[104:119]
    ds_read_b64_tr_b16 v[230:231], v36 offset:15616
    s_waitcnt vmcnt(2)
    v_lshlrev_b32 v52, 16, v52
    s_waitcnt lgkmcnt(10)
    v_mfma_f32_32x32x16_bf16 v[120:135], v[184:187], v[208:211], v[120:135]
    s_waitcnt vmcnt(1)
    v_lshlrev_b32 v53, 16, v53
    s_waitcnt vmcnt(0)
    v_lshlrev_b32 v54, 16, v54
    v_mfma_f32_32x32x16_bf16 v[136:151], v[188:191], v[208:211], v[136:151]
    v_mul_f32 v16, s88, v54
    v_fma_f32 v17, v54, s88, -v16
    s_waitcnt lgkmcnt(8)
    v_mfma_f32_32x32x16_bf16 v[152:167], v[184:187], v[212:215], v[152:167]
    v_mfma_f32_32x32x16_bf16 v[168:183], v[188:191], v[212:215], v[168:183]
    s_waitcnt lgkmcnt(6)
    v_mfma_f32_32x32x16_bf16 v[56:71], v[192:195], v[216:219], v[56:71]
    ds_read_b128 v[184:187], v30 offset:0
    ds_read_b128 v[200:203], v34
    ds_read_b128 v[188:191], v30 offset:2048
    s_waitcnt lgkmcnt(8)
    v_mfma_f32_32x32x16_bf16 v[72:87], v[196:199], v[216:219], v[72:87]
    ds_read_b128 v[204:207], v34 offset:4096
    ds_read_b64_tr_b16 v[208:209], v36 offset:6144
    s_waitcnt lgkmcnt(9)
    v_mfma_f32_32x32x16_bf16 v[88:103], v[192:195], v[220:223], v[88:103]
    ds_read_b64_tr_b16 v[210:211], v36 offset:6400
    ds_read_b64_tr_b16 v[212:213], v36 offset:18432
    v_mfma_f32_32x32x16_bf16 v[104:119], v[196:199], v[220:223], v[104:119]
    ds_read_b64_tr_b16 v[214:215], v36 offset:18688
    v_fma_f32 v17, v54, s89, v17
    s_waitcnt lgkmcnt(10)
    v_mfma_f32_32x32x16_bf16 v[120:135], v[192:195], v[224:227], v[120:135]
    v_exp_f32 v16, v16
    v_mul_f32 v17, s90, v17
    v_mfma_f32_32x32x16_bf16 v[136:151], v[196:199], v[224:227], v[136:151]
    v_fma_f32 v54, v16, v17, v16
    v_cvt_pk_bf16_f32 v54, v54, v54
    s_waitcnt lgkmcnt(8)
    v_mfma_f32_32x32x16_bf16 v[152:167], v[192:195], v[228:231], v[152:167]
    v_mfma_f32_32x32x16_bf16 v[168:183], v[196:199], v[228:231], v[168:183]
    s_waitcnt lgkmcnt(6)
    v_mfma_f32_32x32x16_bf16 v[56:71], v[184:187], v[200:203], v[56:71]
    ds_read_b128 v[192:195], v31 offset:0
    ds_read_b128 v[216:219], v35
    ds_read_b128 v[196:199], v31 offset:2048
    s_waitcnt lgkmcnt(8)
    v_mfma_f32_32x32x16_bf16 v[72:87], v[188:191], v[200:203], v[72:87]
    ds_read_b128 v[220:223], v35 offset:4096
    ds_read_b64_tr_b16 v[224:225], v36 offset:9216
    s_waitcnt lgkmcnt(9)
    v_mfma_f32_32x32x16_bf16 v[88:103], v[184:187], v[204:207], v[88:103]
    ds_read_b64_tr_b16 v[226:227], v36 offset:9472
    ds_read_b64_tr_b16 v[228:229], v36 offset:21504
    v_mfma_f32_32x32x16_bf16 v[104:119], v[188:191], v[204:207], v[104:119]
    ds_read_b64_tr_b16 v[230:231], v36 offset:21760
    v_and_b32 v54, 0xffff0000, v54
    s_waitcnt lgkmcnt(10)
    v_mfma_f32_32x32x16_bf16 v[120:135], v[184:187], v[208:211], v[120:135]
    v_mul_f32 v18, v54, v52
    v_mul_f32 v19, v54, v53
    v_mfma_f32_32x32x16_bf16 v[136:151], v[188:191], v[208:211], v[136:151]
    v_mul_f32 v19, s91, v19
    v_mul_f32 v16, s88, v18
    s_waitcnt lgkmcnt(8)
    v_mfma_f32_32x32x16_bf16 v[152:167], v[184:187], v[212:215], v[152:167]
    v_mfma_f32_32x32x16_bf16 v[168:183], v[188:191], v[212:215], v[168:183]
    s_waitcnt lgkmcnt(0)
    s_barrier
    v_mfma_f32_32x32x16_bf16 v[56:71], v[192:195], v[216:219], v[56:71]
    v_add_u32 v28, 49152, v28
    v_add_u32 v32, 49152, v32
    v_add_u32 v36, 49152, v36
    ds_read_b128 v[184:187], v28 offset:0
    v_mfma_f32_32x32x16_bf16 v[72:87], v[196:199], v[216:219], v[72:87]
    ds_read_b128 v[200:203], v32
    ds_read_b128 v[188:191], v28 offset:2048
    ds_read_b128 v[204:207], v32 offset:4096
    ds_read_b64_tr_b16 v[208:209], v36 offset:0
    v_mfma_f32_32x32x16_bf16 v[88:103], v[192:195], v[220:223], v[88:103]
    ds_read_b64_tr_b16 v[210:211], v36 offset:256
    ds_read_b64_tr_b16 v[212:213], v36 offset:12288
    ds_read_b64_tr_b16 v[214:215], v36 offset:12544
    v_mfma_f32_32x32x16_bf16 v[104:119], v[196:199], v[220:223], v[104:119]
    v_add_u32 v29, 49152, v29
    v_add_u32 v30, 49152, v30
    v_add_u32 v31, 49152, v31
    v_add_u32 v33, 49152, v33
    v_mfma_f32_32x32x16_bf16 v[120:135], v[192:195], v[224:227], v[120:135]
    v_add_u32 v34, 49152, v34
    v_add_u32 v35, 49152, v35
    v_fma_f32 v17, v18, s88, -v16
    v_fma_f32 v17, v18, s89, v17
    v_mfma_f32_32x32x16_bf16 v[136:151], v[196:199], v[224:227], v[136:151]
    v_exp_f32 v16, v16
    v_mul_f32 v17, s90, v17
    v_fma_f32 v18, v16, v17, v16
    v_mfma_f32_32x32x16_bf16 v[152:167], v[192:195], v[228:231], v[152:167]
    v_mfma_f32_32x32x16_bf16 v[168:183], v[196:199], v[228:231], v[168:183]
    s_waitcnt lgkmcnt(6)
    v_mfma_f32_32x32x16_bf16 v[56:71], v[184:187], v[200:203], v[56:71]
    ds_read_b128 v[192:195], v29 offset:0
    ds_read_b128 v[216:219], v33
    ds_read_b128 v[196:199], v29 offset:2048
    s_waitcnt lgkmcnt(8)
    v_mfma_f32_32x32x16_bf16 v[72:87], v[188:191], v[200:203], v[72:87]
    ds_read_b128 v[220:223], v33 offset:4096
    ds_read_b64_tr_b16 v[224:225], v36 offset:3072
    s_waitcnt lgkmcnt(9)
    v_mfma_f32_32x32x16_bf16 v[88:103], v[184:187], v[204:207], v[88:103]
    ds_read_b64_tr_b16 v[226:227], v36 offset:3328
    ds_read_b64_tr_b16 v[228:229], v36 offset:15360
    v_mfma_f32_32x32x16_bf16 v[104:119], v[188:191], v[204:207], v[104:119]
    ds_read_b64_tr_b16 v[230:231], v36 offset:15616
    v_rndne_f32 v20, v19
    s_waitcnt lgkmcnt(10)
    v_mfma_f32_32x32x16_bf16 v[120:135], v[184:187], v[208:211], v[120:135]
    v_sub_f32 v19, v19, v20
    v_cos_f32 v20, v19
    v_mfma_f32_32x32x16_bf16 v[136:151], v[188:191], v[208:211], v[136:151]
    v_sin_f32 v21, v19
    v_mul_f32 v46, v18, v20
    s_waitcnt lgkmcnt(8)
    v_mfma_f32_32x32x16_bf16 v[152:167], v[184:187], v[212:215], v[152:167]
    v_mfma_f32_32x32x16_bf16 v[168:183], v[188:191], v[212:215], v[168:183]
    s_waitcnt lgkmcnt(6)
    v_mfma_f32_32x32x16_bf16 v[56:71], v[192:195], v[216:219], v[56:71]
    ds_read_b128 v[184:187], v30 offset:0
    ds_read_b128 v[200:203], v34
    ds_read_b128 v[188:191], v30 offset:2048
    s_waitcnt lgkmcnt(8)
    v_mfma_f32_32x32x16_bf16 v[72:87], v[196:199], v[216:219], v[72:87]
    ds_read_b128 v[204:207], v34 offset:4096
    ds_read_b64_tr_b16 v[208:209], v36 offset:6144
    s_waitcnt lgkmcnt(9)
    v_mfma_f32_32x32x16_bf16 v[88:103], v[192:195], v[220:223], v[88:103]
    ds_read_b64_tr_b16 v[210:211], v36 offset:6400
    ds_read_b64_tr_b16 v[212:213], v36 offset:18432
    v_mfma_f32_32x32x16_bf16 v[104:119], v[196:199], v[220:223], v[104:119]
    ds_read_b64_tr_b16 v[214:215], v36 offset:18688
    v_mul_f32 v21, v18, v21
    s_waitcnt lgkmcnt(10)
    v_mfma_f32_32x32x16_bf16 v[120:135], v[192:195], v[224:227], v[120:135]
    v_add_f32 v20, -1.0, v46
    v_mul_f32 v16, v52, v52
    v_mfma_f32_32x32x16_bf16 v[136:151], v[196:199], v[224:227], v[136:151]
    v_fma_f32 v16, v53, v53, v16
    v_rcp_f32 v16, v16
    s_waitcnt lgkmcnt(8)
    v_mfma_f32_32x32x16_bf16 v[152:167], v[192:195], v[228:231], v[152:167]
    v_mfma_f32_32x32x16_bf16 v[168:183], v[196:199], v[228:231], v[168:183]
    s_waitcnt lgkmcnt(6)
    v_mfma_f32_32x32x16_bf16 v[56:71], v[184:187], v[200:203], v[56:71]
    ds_read_b128 v[192:195], v31 offset:0
    ds_read_b128 v[216:219], v35
    ds_read_b128 v[196:199], v31 offset:2048
    s_waitcnt lgkmcnt(8)
    v_mfma_f32_32x32x16_bf16 v[72:87], v[188:191], v[200:203], v[72:87]
    ds_read_b128 v[220:223], v35 offset:4096
    ds_read_b64_tr_b16 v[224:225], v36 offset:9216
    s_waitcnt lgkmcnt(9)
    v_mfma_f32_32x32x16_bf16 v[88:103], v[184:187], v[204:207], v[88:103]
    ds_read_b64_tr_b16 v[226:227], v36 offset:9472
    ds_read_b64_tr_b16 v[228:229], v36 offset:21504
    v_mfma_f32_32x32x16_bf16 v[104:119], v[188:191], v[204:207], v[104:119]
    ds_read_b64_tr_b16 v[230:231], v36 offset:21760
    v_mul_f32 v17, v20, v52
    s_waitcnt lgkmcnt(10)
    v_mfma_f32_32x32x16_bf16 v[120:135], v[184:187], v[208:211], v[120:135]
    v_fma_f32 v17, v21, v53, v17
    v_mul_f32 v22, v20, v53
    v_mfma_f32_32x32x16_bf16 v[136:151], v[188:191], v[208:211], v[136:151]
    v_fma_f32 v22, -v21, v52, v22
    v_add_f32 v16, v16, v16
    s_waitcnt lgkmcnt(8)
    v_mfma_f32_32x32x16_bf16 v[152:167], v[184:187], v[212:215], v[152:167]
    v_mfma_f32_32x32x16_bf16 v[168:183], v[188:191], v[212:215], v[168:183]
    s_waitcnt lgkmcnt(0)
    s_barrier
    v_mfma_f32_32x32x16_bf16 v[56:71], v[192:195], v[216:219], v[56:71]
    v_add_u32 v28, 4294868992, v28
    v_add_u32 v32, 4294868992, v32
    v_add_u32 v36, 4294868992, v36
    ds_read_b128 v[184:187], v28 offset:0
    v_mfma_f32_32x32x16_bf16 v[72:87], v[196:199], v[216:219], v[72:87]
    ds_read_b128 v[200:203], v32
    ds_read_b128 v[188:191], v28 offset:2048
    ds_read_b128 v[204:207], v32 offset:4096
    ds_read_b64_tr_b16 v[208:209], v36 offset:0
    v_mfma_f32_32x32x16_bf16 v[88:103], v[192:195], v[220:223], v[88:103]
    ds_read_b64_tr_b16 v[210:211], v36 offset:256
    ds_read_b64_tr_b16 v[212:213], v36 offset:12288
    ds_read_b64_tr_b16 v[214:215], v36 offset:12544
    v_mfma_f32_32x32x16_bf16 v[104:119], v[196:199], v[220:223], v[104:119]
    v_add_u32 v29, 4294868992, v29
    v_add_u32 v30, 4294868992, v30
    v_add_u32 v31, 4294868992, v31
    v_add_u32 v33, 4294868992, v33
    v_mfma_f32_32x32x16_bf16 v[120:135], v[192:195], v[224:227], v[120:135]
    v_add_u32 v34, 4294868992, v34
    v_add_u32 v35, 4294868992, v35
    v_mul_f32 v48, v17, v16
    v_mul_f32 v49, v22, v16
    v_mfma_f32_32x32x16_bf16 v[136:151], v[196:199], v[224:227], v[136:151]
    v_sub_f32 v47, 0, v21
    v_mov_b32 v232, v46
    v_mov_b32 v233, v47
    v_mfma_f32_32x32x16_bf16 v[152:167], v[192:195], v[228:231], v[152:167]
    v_mfma_f32_32x32x16_bf16 v[168:183], v[196:199], v[228:231], v[168:183]
    s_waitcnt lgkmcnt(6)
    v_mfma_f32_32x32x16_bf16 v[56:71], v[184:187], v[200:203], v[56:71]
    ds_read_b128 v[192:195], v29 offset:0
    ds_read_b128 v[216:219], v33
    ds_read_b128 v[196:199], v29 offset:2048
    s_waitcnt lgkmcnt(8)
    v_mfma_f32_32x32x16_bf16 v[72:87], v[188:191], v[200:203], v[72:87]
    ds_read_b128 v[220:223], v33 offset:4096
    ds_read_b64_tr_b16 v[224:225], v36 offset:3072
    s_waitcnt lgkmcnt(9)
    v_mfma_f32_32x32x16_bf16 v[88:103], v[184:187], v[204:207], v[88:103]
    ds_read_b64_tr_b16 v[226:227], v36 offset:3328
    ds_read_b64_tr_b16 v[228:229], v36 offset:15360
    v_mfma_f32_32x32x16_bf16 v[104:119], v[188:191], v[204:207], v[104:119]
    ds_read_b64_tr_b16 v[230:231], v36 offset:15616
    v_mul_f32 v234, v232, v46
    s_waitcnt lgkmcnt(10)
    v_mfma_f32_32x32x16_bf16 v[120:135], v[184:187], v[208:211], v[120:135]
    v_mul_f32 v235, v232, v47
    v_fma_f32 v234, -v233, v47, v234
    v_mfma_f32_32x32x16_bf16 v[136:151], v[188:191], v[208:211], v[136:151]
    v_fma_f32 v235, v233, v46, v235
    v_mul_f32 v236, v234, v46
    s_waitcnt lgkmcnt(8)
    v_mfma_f32_32x32x16_bf16 v[152:167], v[184:187], v[212:215], v[152:167]
    v_mfma_f32_32x32x16_bf16 v[168:183], v[188:191], v[212:215], v[168:183]
    s_waitcnt lgkmcnt(6)
    v_mfma_f32_32x32x16_bf16 v[56:71], v[192:195], v[216:219], v[56:71]
    ds_read_b128 v[184:187], v30 offset:0
    ds_read_b128 v[200:203], v34
    ds_read_b128 v[188:191], v30 offset:2048
    s_waitcnt lgkmcnt(8)
    v_mfma_f32_32x32x16_bf16 v[72:87], v[196:199], v[216:219], v[72:87]
    ds_read_b128 v[204:207], v34 offset:4096
    ds_read_b64_tr_b16 v[208:209], v36 offset:6144
    s_waitcnt lgkmcnt(9)
    v_mfma_f32_32x32x16_bf16 v[88:103], v[192:195], v[220:223], v[88:103]
    ds_read_b64_tr_b16 v[210:211], v36 offset:6400
    ds_read_b64_tr_b16 v[212:213], v36 offset:18432
    v_mfma_f32_32x32x16_bf16 v[104:119], v[196:199], v[220:223], v[104:119]
    ds_read_b64_tr_b16 v[214:215], v36 offset:18688
    v_mul_f32 v237, v234, v47
    s_waitcnt lgkmcnt(10)
    v_mfma_f32_32x32x16_bf16 v[120:135], v[192:195], v[224:227], v[120:135]
    v_fma_f32 v236, -v235, v47, v236
    v_fma_f32 v237, v235, v46, v237
    v_mfma_f32_32x32x16_bf16 v[136:151], v[196:199], v[224:227], v[136:151]
    v_mul_f32 v238, v236, v46
    v_mul_f32 v239, v236, v47
    s_waitcnt lgkmcnt(8)
    v_mfma_f32_32x32x16_bf16 v[152:167], v[192:195], v[228:231], v[152:167]
    v_mfma_f32_32x32x16_bf16 v[168:183], v[196:199], v[228:231], v[168:183]
    s_waitcnt lgkmcnt(6)
    v_mfma_f32_32x32x16_bf16 v[56:71], v[184:187], v[200:203], v[56:71]
    ds_read_b128 v[192:195], v31 offset:0
    ds_read_b128 v[216:219], v35
    ds_read_b128 v[196:199], v31 offset:2048
    s_waitcnt lgkmcnt(8)
    v_mfma_f32_32x32x16_bf16 v[72:87], v[188:191], v[200:203], v[72:87]
    ds_read_b128 v[220:223], v35 offset:4096
    ds_read_b64_tr_b16 v[224:225], v36 offset:9216
    s_waitcnt lgkmcnt(9)
    v_mfma_f32_32x32x16_bf16 v[88:103], v[184:187], v[204:207], v[88:103]
    ds_read_b64_tr_b16 v[226:227], v36 offset:9472
    ds_read_b64_tr_b16 v[228:229], v36 offset:21504
    v_mfma_f32_32x32x16_bf16 v[104:119], v[188:191], v[204:207], v[104:119]
    ds_read_b64_tr_b16 v[230:231], v36 offset:21760
    v_fma_f32 v238, -v237, v47, v238
    s_waitcnt lgkmcnt(10)
    v_mfma_f32_32x32x16_bf16 v[120:135], v[184:187], v[208:211], v[120:135]
    v_fma_f32 v239, v237, v46, v239
    v_mul_f32 v240, v238, v46
    v_mfma_f32_32x32x16_bf16 v[136:151], v[188:191], v[208:211], v[136:151]
    v_mul_f32 v241, v238, v47
    v_fma_f32 v240, -v239, v47, v240
    s_waitcnt lgkmcnt(8)
    v_mfma_f32_32x32x16_bf16 v[152:167], v[184:187], v[212:215], v[152:167]
    v_mfma_f32_32x32x16_bf16 v[168:183], v[188:191], v[212:215], v[168:183]
    s_waitcnt lgkmcnt(0)
    s_barrier
    v_mfma_f32_32x32x16_bf16 v[56:71], v[192:195], v[216:219], v[56:71]
    v_add_u32 v28, 49152, v28
    v_add_u32 v32, 49152, v32
    v_add_u32 v36, 49152, v36
    ds_read_b128 v[184:187], v28 offset:0
    v_mfma_f32_32x32x16_bf16 v[72:87], v[196:199], v[216:219], v[72:87]
    ds_read_b128 v[200:203], v32
    ds_read_b128 v[188:191], v28 offset:2048
    ds_read_b128 v[204:207], v32 offset:4096
    ds_read_b64_tr_b16 v[208:209], v36 offset:0
    v_mfma_f32_32x32x16_bf16 v[88:103], v[192:195], v[220:223], v[88:103]
    ds_read_b64_tr_b16 v[210:211], v36 offset:256
    ds_read_b64_tr_b16 v[212:213], v36 offset:12288
    ds_read_b64_tr_b16 v[214:215], v36 offset:12544
    v_mfma_f32_32x32x16_bf16 v[104:119], v[196:199], v[220:223], v[104:119]
    v_add_u32 v29, 49152, v29
    v_add_u32 v30, 49152, v30
    v_add_u32 v31, 49152, v31
    v_add_u32 v33, 49152, v33
    v_mfma_f32_32x32x16_bf16 v[120:135], v[192:195], v[224:227], v[120:135]
    v_add_u32 v34, 49152, v34
    v_add_u32 v35, 49152, v35
    v_fma_f32 v241, v239, v46, v241
    v_mul_f32 v242, v240, v46
    v_mfma_f32_32x32x16_bf16 v[136:151], v[196:199], v[224:227], v[136:151]
    v_mul_f32 v243, v240, v47
    v_fma_f32 v242, -v241, v47, v242
    v_fma_f32 v243, v241, v46, v243
    v_mfma_f32_32x32x16_bf16 v[152:167], v[192:195], v[228:231], v[152:167]
    v_mfma_f32_32x32x16_bf16 v[168:183], v[196:199], v[228:231], v[168:183]
    s_waitcnt lgkmcnt(6)
    v_mfma_f32_32x32x16_bf16 v[56:71], v[184:187], v[200:203], v[56:71]
    ds_read_b128 v[192:195], v29 offset:0
    ds_read_b128 v[216:219], v33
    ds_read_b128 v[196:199], v29 offset:2048
    s_waitcnt lgkmcnt(8)
    v_mfma_f32_32x32x16_bf16 v[72:87], v[188:191], v[200:203], v[72:87]
    ds_read_b128 v[220:223], v33 offset:4096
    ds_read_b64_tr_b16 v[224:225], v36 offset:3072
    s_waitcnt lgkmcnt(9)
    v_mfma_f32_32x32x16_bf16 v[88:103], v[184:187], v[204:207], v[88:103]
    ds_read_b64_tr_b16 v[226:227], v36 offset:3328
    ds_read_b64_tr_b16 v[228:229], v36 offset:15360
    v_mfma_f32_32x32x16_bf16 v[104:119], v[188:191], v[204:207], v[104:119]
    ds_read_b64_tr_b16 v[230:231], v36 offset:15616
    v_mul_f32 v244, v242, v46
    s_waitcnt lgkmcnt(10)
    v_mfma_f32_32x32x16_bf16 v[120:135], v[184:187], v[208:211], v[120:135]
    v_mul_f32 v245, v242, v47
    v_fma_f32 v244, -v243, v47, v244
    v_mfma_f32_32x32x16_bf16 v[136:151], v[188:191], v[208:211], v[136:151]
    v_fma_f32 v245, v243, v46, v245
    v_mul_f32 v246, v244, v46
    s_waitcnt lgkmcnt(8)
    v_mfma_f32_32x32x16_bf16 v[152:167], v[184:187], v[212:215], v[152:167]
    v_mfma_f32_32x32x16_bf16 v[168:183], v[188:191], v[212:215], v[168:183]
    s_waitcnt lgkmcnt(6)
    v_mfma_f32_32x32x16_bf16 v[56:71], v[192:195], v[216:219], v[56:71]
    ds_read_b128 v[184:187], v30 offset:0
    ds_read_b128 v[200:203], v34
    s_waitcnt lgkmcnt(7)
    v_mfma_f32_32x32x16_bf16 v[72:87], v[196:199], v[216:219], v[72:87]
    ds_read_b128 v[188:191], v30 offset:2048
    ds_read_b128 v[204:207], v34 offset:4096
    s_waitcnt lgkmcnt(8)
    v_mfma_f32_32x32x16_bf16 v[88:103], v[192:195], v[220:223], v[88:103]
    ds_read_b64_tr_b16 v[208:209], v36 offset:6144
    ds_read_b64_tr_b16 v[210:211], v36 offset:6400
    v_mfma_f32_32x32x16_bf16 v[104:119], v[196:199], v[220:223], v[104:119]
    ds_read_b64_tr_b16 v[212:213], v36 offset:18432
    ds_read_b64_tr_b16 v[214:215], v36 offset:18688
    s_waitcnt lgkmcnt(10)
    v_mfma_f32_32x32x16_bf16 v[120:135], v[192:195], v[224:227], v[120:135]
    v_mul_f32 v247, v244, v47
    v_fma_f32 v246, -v245, v47, v246
    v_mfma_f32_32x32x16_bf16 v[136:151], v[196:199], v[224:227], v[136:151]
    v_fma_f32 v247, v245, v46, v247
    s_waitcnt lgkmcnt(8)
    v_mfma_f32_32x32x16_bf16 v[152:167], v[192:195], v[228:231], v[152:167]
    v_mfma_f32_32x32x16_bf16 v[168:183], v[196:199], v[228:231], v[168:183]
    s_waitcnt lgkmcnt(6)
    v_mfma_f32_32x32x16_bf16 v[56:71], v[184:187], v[200:203], v[56:71]
    ds_read_b128 v[192:195], v31 offset:0
    ds_read_b128 v[216:219], v35
    s_waitcnt lgkmcnt(7)
    v_mfma_f32_32x32x16_bf16 v[72:87], v[188:191], v[200:203], v[72:87]
    ds_read_b128 v[196:199], v31 offset:2048
    s_waitcnt lgkmcnt(7)
    v_mfma_f32_32x32x16_bf16 v[88:103], v[184:187], v[204:207], v[88:103]
    ds_read_b128 v[220:223], v35 offset:4096
    v_mfma_f32_32x32x16_bf16 v[104:119], v[188:191], v[204:207], v[104:119]
    ds_read_b64_tr_b16 v[224:225], v36 offset:9216
    ds_read_b64_tr_b16 v[226:227], v36 offset:9472
    s_waitcnt lgkmcnt(8)
    v_mfma_f32_32x32x16_bf16 v[120:135], v[184:187], v[208:211], v[120:135]
    ds_read_b64_tr_b16 v[228:229], v36 offset:21504
    v_mfma_f32_32x32x16_bf16 v[136:151], v[188:191], v[208:211], v[136:151]
    ds_read_b64_tr_b16 v[230:231], v36 offset:21760
    s_waitcnt lgkmcnt(8)
    v_mfma_f32_32x32x16_bf16 v[152:167], v[184:187], v[212:215], v[152:167]
    v_mfma_f32_32x32x16_bf16 v[168:183], v[188:191], v[212:215], v[168:183]
    s_waitcnt lgkmcnt(0)
    s_barrier
    v_mfma_f32_32x32x16_bf16 v[56:71], v[192:195], v[216:219], v[56:71]
    v_add_u32 v28, 49152, v28
    v_add_u32 v32, 49152, v32
    v_add_u32 v36, 49152, v36
    v_mfma_f32_32x32x16_bf16 v[72:87], v[196:199], v[216:219], v[72:87]
    ds_read_b128 v[184:187], v28 offset:0
    ds_read_b128 v[200:203], v32
    ds_read_b128 v[188:191], v28 offset:2048
    v_mfma_f32_32x32x16_bf16 v[88:103], v[192:195], v[220:223], v[88:103]
    ds_read_b128 v[204:207], v32 offset:4096
    ds_read_b64_tr_b16 v[208:209], v36 offset:0
    ds_read_b64_tr_b16 v[210:211], v36 offset:256
    v_mfma_f32_32x32x16_bf16 v[104:119], v[196:199], v[220:223], v[104:119]
    ds_read_b64_tr_b16 v[212:213], v36 offset:12288
    ds_read_b64_tr_b16 v[214:215], v36 offset:12544
    v_add_u32 v29, 49152, v29
    v_mfma_f32_32x32x16_bf16 v[120:135], v[192:195], v[224:227], v[120:135]
    v_add_u32 v30, 49152, v30
    v_add_u32 v31, 49152, v31
    v_add_u32 v33, 49152, v33
    v_mfma_f32_32x32x16_bf16 v[136:151], v[196:199], v[224:227], v[136:151]
    v_add_u32 v34, 49152, v34
    v_add_u32 v35, 49152, v35
    v_mfma_f32_32x32x16_bf16 v[152:167], v[192:195], v[228:231], v[152:167]
    v_mfma_f32_32x32x16_bf16 v[168:183], v[196:199], v[228:231], v[168:183]
    s_waitcnt lgkmcnt(6)
    v_mfma_f32_32x32x16_bf16 v[56:71], v[184:187], v[200:203], v[56:71]
    ds_read_b128 v[192:195], v29 offset:0
    ds_read_b128 v[216:219], v33
    s_waitcnt lgkmcnt(7)
    v_mfma_f32_32x32x16_bf16 v[72:87], v[188:191], v[200:203], v[72:87]
    ds_read_b128 v[196:199], v29 offset:2048
    s_waitcnt lgkmcnt(7)
    v_mfma_f32_32x32x16_bf16 v[88:103], v[184:187], v[204:207], v[88:103]
    ds_read_b128 v[220:223], v33 offset:4096
    v_mfma_f32_32x32x16_bf16 v[104:119], v[188:191], v[204:207], v[104:119]
    ds_read_b64_tr_b16 v[224:225], v36 offset:3072
    ds_read_b64_tr_b16 v[226:227], v36 offset:3328
    s_waitcnt lgkmcnt(8)
    v_mfma_f32_32x32x16_bf16 v[120:135], v[184:187], v[208:211], v[120:135]
    ds_read_b64_tr_b16 v[228:229], v36 offset:15360
    v_mfma_f32_32x32x16_bf16 v[136:151], v[188:191], v[208:211], v[136:151]
    ds_read_b64_tr_b16 v[230:231], v36 offset:15616
    s_waitcnt lgkmcnt(8)
    v_mfma_f32_32x32x16_bf16 v[152:167], v[184:187], v[212:215], v[152:167]
    v_mfma_f32_32x32x16_bf16 v[168:183], v[188:191], v[212:215], v[168:183]
    s_waitcnt lgkmcnt(6)
    v_mfma_f32_32x32x16_bf16 v[56:71], v[192:195], v[216:219], v[56:71]
    ds_read_b128 v[184:187], v30 offset:0
    ds_read_b128 v[200:203], v34
    s_waitcnt lgkmcnt(7)
    v_mfma_f32_32x32x16_bf16 v[72:87], v[196:199], v[216:219], v[72:87]
    ds_read_b128 v[188:191], v30 offset:2048
    s_waitcnt lgkmcnt(7)
    v_mfma_f32_32x32x16_bf16 v[88:103], v[192:195], v[220:223], v[88:103]
    ds_read_b128 v[204:207], v34 offset:4096
    v_mfma_f32_32x32x16_bf16 v[104:119], v[196:199], v[220:223], v[104:119]
    ds_read_b64_tr_b16 v[208:209], v36 offset:6144
    ds_read_b64_tr_b16 v[210:211], v36 offset:6400
    s_waitcnt lgkmcnt(8)
    v_mfma_f32_32x32x16_bf16 v[120:135], v[192:195], v[224:227], v[120:135]
    ds_read_b64_tr_b16 v[212:213], v36 offset:18432
    v_mfma_f32_32x32x16_bf16 v[136:151], v[196:199], v[224:227], v[136:151]
    ds_read_b64_tr_b16 v[214:215], v36 offset:18688
    s_waitcnt lgkmcnt(8)
    v_mfma_f32_32x32x16_bf16 v[152:167], v[192:195], v[228:231], v[152:167]
    v_mfma_f32_32x32x16_bf16 v[168:183], v[196:199], v[228:231], v[168:183]
    s_waitcnt lgkmcnt(6)
    v_mfma_f32_32x32x16_bf16 v[56:71], v[184:187], v[200:203], v[56:71]
    ds_read_b128 v[192:195], v31 offset:0
    ds_read_b128 v[216:219], v35
    s_waitcnt lgkmcnt(7)
    v_mfma_f32_32x32x16_bf16 v[72:87], v[188:191], v[200:203], v[72:87]
    ds_read_b128 v[196:199], v31 offset:2048
    s_waitcnt lgkmcnt(7)
    v_mfma_f32_32x32x16_bf16 v[88:103], v[184:187], v[204:207], v[88:103]
    ds_read_b128 v[220:223], v35 offset:4096
    v_mfma_f32_32x32x16_bf16 v[104:119], v[188:191], v[204:207], v[104:119]
    ds_read_b64_tr_b16 v[224:225], v36 offset:9216
    ds_read_b64_tr_b16 v[226:227], v36 offset:9472
    s_waitcnt lgkmcnt(8)
    v_mfma_f32_32x32x16_bf16 v[120:135], v[184:187], v[208:211], v[120:135]
    ds_read_b64_tr_b16 v[228:229], v36 offset:21504
    v_mfma_f32_32x32x16_bf16 v[136:151], v[188:191], v[208:211], v[136:151]
    ds_read_b64_tr_b16 v[230:231], v36 offset:21760
    s_waitcnt lgkmcnt(8)
    v_mfma_f32_32x32x16_bf16 v[152:167], v[184:187], v[212:215], v[152:167]
    v_mfma_f32_32x32x16_bf16 v[168:183], v[188:191], v[212:215], v[168:183]
    s_waitcnt lgkmcnt(0)
    s_barrier
    v_mfma_f32_32x32x16_bf16 v[56:71], v[192:195], v[216:219], v[56:71]
    v_add_u32 v28, 4294868992, v28
    v_add_u32 v32, 4294868992, v32
    v_add_u32 v36, 4294868992, v36
    v_mfma_f32_32x32x16_bf16 v[72:87], v[196:199], v[216:219], v[72:87]
    ds_read_b128 v[184:187], v28 offset:0
    ds_read_b128 v[200:203], v32
    ds_read_b128 v[188:191], v28 offset:2048
    v_mfma_f32_32x32x16_bf16 v[88:103], v[192:195], v[220:223], v[88:103]
    ds_read_b128 v[204:207], v32 offset:4096
    ds_read_b64_tr_b16 v[208:209], v36 offset:0
    ds_read_b64_tr_b16 v[210:211], v36 offset:256
    v_mfma_f32_32x32x16_bf16 v[104:119], v[196:199], v[220:223], v[104:119]
    ds_read_b64_tr_b16 v[212:213], v36 offset:12288
    ds_read_b64_tr_b16 v[214:215], v36 offset:12544
    v_add_u32 v29, 4294868992, v29
    v_mfma_f32_32x32x16_bf16 v[120:135], v[192:195], v[224:227], v[120:135]
    v_add_u32 v30, 4294868992, v30
    v_add_u32 v31, 4294868992, v31
    v_add_u32 v33, 4294868992, v33
    v_mfma_f32_32x32x16_bf16 v[136:151], v[196:199], v[224:227], v[136:151]
    v_add_u32 v34, 4294868992, v34
    v_add_u32 v35, 4294868992, v35
    v_mfma_f32_32x32x16_bf16 v[152:167], v[192:195], v[228:231], v[152:167]
    v_mfma_f32_32x32x16_bf16 v[168:183], v[196:199], v[228:231], v[168:183]
    s_waitcnt lgkmcnt(6)
    v_mfma_f32_32x32x16_bf16 v[56:71], v[184:187], v[200:203], v[56:71]
    ds_read_b128 v[192:195], v29 offset:0
    ds_read_b128 v[216:219], v33
    s_waitcnt lgkmcnt(7)
    v_mfma_f32_32x32x16_bf16 v[72:87], v[188:191], v[200:203], v[72:87]
    ds_read_b128 v[196:199], v29 offset:2048
    s_waitcnt lgkmcnt(7)
    v_mfma_f32_32x32x16_bf16 v[88:103], v[184:187], v[204:207], v[88:103]
    ds_read_b128 v[220:223], v33 offset:4096
    ds_read_b64_tr_b16 v[224:225], v36 offset:3072
    v_mfma_f32_32x32x16_bf16 v[104:119], v[188:191], v[204:207], v[104:119]
    ds_read_b64_tr_b16 v[226:227], v36 offset:3328
    s_waitcnt lgkmcnt(8)
    v_mfma_f32_32x32x16_bf16 v[120:135], v[184:187], v[208:211], v[120:135]
    ds_read_b64_tr_b16 v[228:229], v36 offset:15360
    ds_read_b64_tr_b16 v[230:231], v36 offset:15616
    v_mfma_f32_32x32x16_bf16 v[136:151], v[188:191], v[208:211], v[136:151]
    global_load_dwordx2 v[44:45], v4, s[40:41] sc0 sc1
    s_waitcnt lgkmcnt(8)
    v_mfma_f32_32x32x16_bf16 v[152:167], v[184:187], v[212:215], v[152:167]
    v_mfma_f32_32x32x16_bf16 v[168:183], v[188:191], v[212:215], v[168:183]
    s_waitcnt lgkmcnt(6)
    v_mfma_f32_32x32x16_bf16 v[56:71], v[192:195], v[216:219], v[56:71]
    ds_read_b128 v[184:187], v30 offset:0
    ds_read_b128 v[200:203], v34
    s_waitcnt lgkmcnt(7)
    v_mfma_f32_32x32x16_bf16 v[72:87], v[196:199], v[216:219], v[72:87]
    ds_read_b128 v[188:191], v30 offset:2048
    s_waitcnt lgkmcnt(7)
    v_mfma_f32_32x32x16_bf16 v[88:103], v[192:195], v[220:223], v[88:103]
    ds_read_b128 v[204:207], v34 offset:4096
    v_mfma_f32_32x32x16_bf16 v[104:119], v[196:199], v[220:223], v[104:119]
    ds_read_b64_tr_b16 v[208:209], v36 offset:6144
    ds_read_b64_tr_b16 v[210:211], v36 offset:6400
    s_waitcnt lgkmcnt(8)
    v_mfma_f32_32x32x16_bf16 v[120:135], v[192:195], v[224:227], v[120:135]
    ds_read_b64_tr_b16 v[212:213], v36 offset:18432
    v_mfma_f32_32x32x16_bf16 v[136:151], v[196:199], v[224:227], v[136:151]
    ds_read_b64_tr_b16 v[214:215], v36 offset:18688
    s_waitcnt lgkmcnt(8)
    v_mfma_f32_32x32x16_bf16 v[152:167], v[192:195], v[228:231], v[152:167]
    v_mfma_f32_32x32x16_bf16 v[168:183], v[196:199], v[228:231], v[168:183]
    s_waitcnt lgkmcnt(6)
    v_mfma_f32_32x32x16_bf16 v[56:71], v[184:187], v[200:203], v[56:71]
    ds_read_b128 v[192:195], v31 offset:0
    ds_read_b128 v[216:219], v35
    s_waitcnt lgkmcnt(7)
    v_mfma_f32_32x32x16_bf16 v[72:87], v[188:191], v[200:203], v[72:87]
    ds_read_b128 v[196:199], v31 offset:2048
    s_waitcnt lgkmcnt(7)
    v_mfma_f32_32x32x16_bf16 v[88:103], v[184:187], v[204:207], v[88:103]
    ds_read_b128 v[220:223], v35 offset:4096
    v_mfma_f32_32x32x16_bf16 v[104:119], v[188:191], v[204:207], v[104:119]
    ds_read_b64_tr_b16 v[224:225], v36 offset:9216
    ds_read_b64_tr_b16 v[226:227], v36 offset:9472
    s_waitcnt lgkmcnt(8)
    v_mfma_f32_32x32x16_bf16 v[120:135], v[184:187], v[208:211], v[120:135]
    ds_read_b64_tr_b16 v[228:229], v36 offset:21504
    v_mfma_f32_32x32x16_bf16 v[136:151], v[188:191], v[208:211], v[136:151]
    ds_read_b64_tr_b16 v[230:231], v36 offset:21760
    s_waitcnt lgkmcnt(8)
    v_mfma_f32_32x32x16_bf16 v[152:167], v[184:187], v[212:215], v[152:167]
    v_mfma_f32_32x32x16_bf16 v[168:183], v[188:191], v[212:215], v[168:183]
    s_waitcnt lgkmcnt(0)
    s_barrier
    v_mfma_f32_32x32x16_bf16 v[56:71], v[192:195], v[216:219], v[56:71]
    v_add_u32 v28, 49152, v28
    v_add_u32 v32, 49152, v32
    v_add_u32 v36, 49152, v36
    v_mfma_f32_32x32x16_bf16 v[72:87], v[196:199], v[216:219], v[72:87]
    ds_read_b128 v[184:187], v28 offset:0
    ds_read_b128 v[200:203], v32
    ds_read_b128 v[188:191], v28 offset:2048
    v_mfma_f32_32x32x16_bf16 v[88:103], v[192:195], v[220:223], v[88:103]
    ds_read_b128 v[204:207], v32 offset:4096
    ds_read_b64_tr_b16 v[208:209], v36 offset:0
    ds_read_b64_tr_b16 v[210:211], v36 offset:256
    v_mfma_f32_32x32x16_bf16 v[104:119], v[196:199], v[220:223], v[104:119]
    ds_read_b64_tr_b16 v[212:213], v36 offset:12288
    ds_read_b64_tr_b16 v[214:215], v36 offset:12544
    v_add_u32 v29, 49152, v29
    v_mfma_f32_32x32x16_bf16 v[120:135], v[192:195], v[224:227], v[120:135]
    v_add_u32 v30, 49152, v30
    v_add_u32 v31, 49152, v31
    v_add_u32 v33, 49152, v33
    v_mfma_f32_32x32x16_bf16 v[136:151], v[196:199], v[224:227], v[136:151]
    v_add_u32 v34, 49152, v34
    v_add_u32 v35, 49152, v35
    v_mfma_f32_32x32x16_bf16 v[152:167], v[192:195], v[228:231], v[152:167]
    v_mfma_f32_32x32x16_bf16 v[168:183], v[196:199], v[228:231], v[168:183]
    s_waitcnt lgkmcnt(6)
    v_mfma_f32_32x32x16_bf16 v[56:71], v[184:187], v[200:203], v[56:71]
    ds_read_b128 v[192:195], v29 offset:0
    ds_read_b128 v[216:219], v33
    s_waitcnt lgkmcnt(7)
    v_mfma_f32_32x32x16_bf16 v[72:87], v[188:191], v[200:203], v[72:87]
    ds_read_b128 v[196:199], v29 offset:2048
    s_waitcnt lgkmcnt(7)
    v_mfma_f32_32x32x16_bf16 v[88:103], v[184:187], v[204:207], v[88:103]
    ds_read_b128 v[220:223], v33 offset:4096
    v_mfma_f32_32x32x16_bf16 v[104:119], v[188:191], v[204:207], v[104:119]
    ds_read_b64_tr_b16 v[224:225], v36 offset:3072
    ds_read_b64_tr_b16 v[226:227], v36 offset:3328
    s_waitcnt lgkmcnt(8)
    v_mfma_f32_32x32x16_bf16 v[120:135], v[184:187], v[208:211], v[120:135]
    ds_read_b64_tr_b16 v[228:229], v36 offset:15360
    v_mfma_f32_32x32x16_bf16 v[136:151], v[188:191], v[208:211], v[136:151]
    ds_read_b64_tr_b16 v[230:231], v36 offset:15616
    s_waitcnt lgkmcnt(8)
    v_mfma_f32_32x32x16_bf16 v[152:167], v[184:187], v[212:215], v[152:167]
    v_mfma_f32_32x32x16_bf16 v[168:183], v[188:191], v[212:215], v[168:183]
    s_waitcnt lgkmcnt(6)
    v_mfma_f32_32x32x16_bf16 v[56:71], v[192:195], v[216:219], v[56:71]
    ds_read_b128 v[184:187], v30 offset:0
    ds_read_b128 v[200:203], v34
    s_waitcnt lgkmcnt(7)
    v_mfma_f32_32x32x16_bf16 v[72:87], v[196:199], v[216:219], v[72:87]
    ds_read_b128 v[188:191], v30 offset:2048
    s_waitcnt lgkmcnt(7)
    v_mfma_f32_32x32x16_bf16 v[88:103], v[192:195], v[220:223], v[88:103]
    ds_read_b128 v[204:207], v34 offset:4096
    v_mfma_f32_32x32x16_bf16 v[104:119], v[196:199], v[220:223], v[104:119]
    ds_read_b64_tr_b16 v[208:209], v36 offset:6144
    ds_read_b64_tr_b16 v[210:211], v36 offset:6400
    s_waitcnt lgkmcnt(8)
    v_mfma_f32_32x32x16_bf16 v[120:135], v[192:195], v[224:227], v[120:135]
    ds_read_b64_tr_b16 v[212:213], v36 offset:18432
    v_mfma_f32_32x32x16_bf16 v[136:151], v[196:199], v[224:227], v[136:151]
    ds_read_b64_tr_b16 v[214:215], v36 offset:18688
    s_waitcnt lgkmcnt(8)
    v_mfma_f32_32x32x16_bf16 v[152:167], v[192:195], v[228:231], v[152:167]
    v_mfma_f32_32x32x16_bf16 v[168:183], v[196:199], v[228:231], v[168:183]
    s_waitcnt lgkmcnt(6)
    v_mfma_f32_32x32x16_bf16 v[56:71], v[184:187], v[200:203], v[56:71]
    ds_read_b128 v[192:195], v31 offset:0
    ds_read_b128 v[216:219], v35
    ds_read_b128 v[196:199], v31 offset:2048
    ds_read_b128 v[220:223], v35 offset:4096
    s_waitcnt lgkmcnt(9)
    v_mfma_f32_32x32x16_bf16 v[72:87], v[188:191], v[200:203], v[72:87]
    ds_read_b64_tr_b16 v[224:225], v36 offset:9216
    ds_read_b64_tr_b16 v[226:227], v36 offset:9472
    ds_read_b64_tr_b16 v[228:229], v36 offset:21504
    ds_read_b64_tr_b16 v[230:231], v36 offset:21760
    s_waitcnt lgkmcnt(12)
    v_mfma_f32_32x32x16_bf16 v[88:103], v[184:187], v[204:207], v[88:103]
    v_cmp_eq_u32 vcc, 1, v2
    v_mov_b32 v11, 154112
    v_add_u32 v16, 0, v37
    v_mfma_f32_32x32x16_bf16 v[104:119], v[188:191], v[204:207], v[104:119]
    v_cndmask_b32 v16, v16, v11, vcc
    v_add_u32 v17, 256, v37
    v_cndmask_b32 v17, v17, v11, vcc
    v_add_u32 v18, 0, v38
    s_waitcnt lgkmcnt(10)
    v_mfma_f32_32x32x16_bf16 v[120:135], v[184:187], v[208:211], v[120:135]
    v_cndmask_b32 v18, v18, v11, vcc
    v_add_u32 v19, 512, v38
    v_cndmask_b32 v19, v19, v11, vcc
    v_add_u32 v20, 1024, v38
    v_mfma_f32_32x32x16_bf16 v[136:151], v[188:191], v[208:211], v[136:151]
    v_cndmask_b32 v20, v20, v11, vcc
    v_add_u32 v21, 1536, v38
    v_cndmask_b32 v21, v21, v11, vcc
    s_waitcnt lgkmcnt(8)
    v_mfma_f32_32x32x16_bf16 v[152:167], v[184:187], v[212:215], v[152:167]
    v_mfma_f32_32x32x16_bf16 v[168:183], v[188:191], v[212:215], v[168:183]
    s_waitcnt lgkmcnt(0)
    s_barrier
    v_mfma_f32_32x32x16_bf16 v[56:71], v[192:195], v[216:219], v[56:71]
    ds_read_b128 v[184:187], v16
    v_mfma_f32_32x32x16_bf16 v[72:87], v[196:199], v[216:219], v[72:87]
    ds_read_b128 v[188:191], v17
    v_mfma_f32_32x32x16_bf16 v[88:103], v[192:195], v[220:223], v[88:103]
    ds_read_b128 v[200:203], v18
    v_mfma_f32_32x32x16_bf16 v[104:119], v[196:199], v[220:223], v[104:119]
    ds_read_b128 v[204:207], v19
    v_mfma_f32_32x32x16_bf16 v[120:135], v[192:195], v[224:227], v[120:135]
    ds_read_b128 v[208:211], v20
    v_mfma_f32_32x32x16_bf16 v[136:151], v[196:199], v[224:227], v[136:151]
    ds_read_b128 v[212:215], v21
    v_mfma_f32_32x32x16_bf16 v[152:167], v[192:195], v[228:231], v[152:167]
    v_mfma_f32_32x32x16_bf16 v[168:183], v[196:199], v[228:231], v[168:183]
    s_waitcnt lgkmcnt(1)
    v_mfma_f32_32x32x16_bf16 v[120:135], v[184:187], v[208:211], v[120:135]
    v_mfma_f32_32x32x16_bf16 v[136:151], v[188:191], v[208:211], v[136:151]
    s_waitcnt lgkmcnt(0)
    v_mfma_f32_32x32x16_bf16 v[152:167], v[184:187], v[212:215], v[152:167]
    v_mfma_f32_32x32x16_bf16 v[168:183], v[188:191], v[212:215], v[168:183]
    v_mfma_f32_32x32x16_bf16 v[56:71], v[184:187], v[200:203], v[56:71]
    v_mfma_f32_32x32x16_bf16 v[72:87], v[188:191], v[200:203], v[72:87]
    v_mfma_f32_32x32x16_bf16 v[88:103], v[184:187], v[204:207], v[88:103]
    v_mfma_f32_32x32x16_bf16 v[104:119], v[188:191], v[204:207], v[104:119]
    s_waitcnt vmcnt(0)
    v_readfirstlane_b32 s46, v44
    v_readfirstlane_b32 s47, v45
    s_cmp_lg_u32 s46, 0
    s_cbranch_scc1 L_cn0_ok
L_cn0_retry:
    s_add_u32 s3, s3, 1
    s_cmp_gt_u32 s3, 1048576
    s_cbranch_scc1 L_cn0_ok
    global_load_dwordx2 v[44:45], v4, s[40:41] sc0 sc1
    s_waitcnt vmcnt(0)
    v_readfirstlane_b32 s46, v44
    v_readfirstlane_b32 s47, v45
    s_nop 1
    s_cmp_lg_u32 s46, 0
    s_cbranch_scc0 L_cn0_retry
L_cn0_ok:
    s_nop 4
    v_max_f32 v120, 0, v120
    v_max_f32 v121, 0, v121
    v_max_f32 v122, 0, v122
    v_max_f32 v123, 0, v123
    v_max_f32 v124, 0, v124
    v_max_f32 v125, 0, v125
    v_max_f32 v126, 0, v126
    v_max_f32 v127, 0, v127
    v_max_f32 v128, 0, v128
    v_max_f32 v129, 0, v129
    v_max_f32 v130, 0, v130
    v_max_f32 v131, 0, v131
    v_max_f32 v132, 0, v132
    v_max_f32 v133, 0, v133
    v_max_f32 v134, 0, v134
    v_max_f32 v135, 0, v135
    v_pk_mul_f32 v[120:121], v[120:121], v[152:153]
    v_pk_mul_f32 v[122:123], v[122:123], v[154:155]
    v_pk_mul_f32 v[124:125], v[124:125], v[156:157]
    v_pk_mul_f32 v[126:127], v[126:127], v[158:159]
    v_pk_mul_f32 v[128:129], v[128:129], v[160:161]
    v_pk_mul_f32 v[130:131], v[130:131], v[162:163]
    v_pk_mul_f32 v[132:133], v[132:133], v[164:165]
    v_pk_mul_f32 v[134:135], v[134:135], v[166:167]
    v_cvt_pk_bf16_f32 v184, v120, v122
    v_cvt_pk_bf16_f32 v185, v124, v126
    v_cvt_pk_bf16_f32 v186, v128, v130
    v_cvt_pk_bf16_f32 v187, v132, v134
    buffer_store_dwordx4 v[184:187], v40, s[64:67], s86 offen offset:0 sc0 sc1
    v_cvt_pk_bf16_f32 v188, v121, v123
    v_cvt_pk_bf16_f32 v189, v125, v127
    v_cvt_pk_bf16_f32 v190, v129, v131
    v_cvt_pk_bf16_f32 v191, v133, v135
    buffer_store_dwordx4 v[188:191], v41, s[64:67], s86 offen offset:0 sc0 sc1
    ds_read_b128 v[200:203], v39 offset:0
    ds_read_b128 v[204:207], v39 offset:16
    ds_read_b128 v[208:211], v39 offset:32
    ds_read_b128 v[212:215], v39 offset:48
    ds_read_b128 v[216:219], v39 offset:64
    ds_read_b128 v[220:223], v39 offset:80
    ds_read_b128 v[224:227], v39 offset:96
    ds_read_b128 v[228:231], v39 offset:112
    v_max_f32 v136, 0, v136
    v_max_f32 v137, 0, v137
    v_max_f32 v138, 0, v138
    v_max_f32 v139, 0, v139
    v_max_f32 v140, 0, v140
    v_max_f32 v141, 0, v141
    v_max_f32 v142, 0, v142
    v_max_f32 v143, 0, v143
    v_max_f32 v144, 0, v144
    v_max_f32 v145, 0, v145
    v_max_f32 v146, 0, v146
    v_max_f32 v147, 0, v147
    v_max_f32 v148, 0, v148
    v_max_f32 v149, 0, v149
    v_max_f32 v150, 0, v150
    v_max_f32 v151, 0, v151
    v_pk_mul_f32 v[136:137], v[136:137], v[168:169]
    v_pk_mul_f32 v[138:139], v[138:139], v[170:171]
    v_pk_mul_f32 v[140:141], v[140:141], v[172:173]
    v_pk_mul_f32 v[142:143], v[142:143], v[174:175]
    v_pk_mul_f32 v[144:145], v[144:145], v[176:177]
    v_pk_mul_f32 v[146:147], v[146:147], v[178:179]
    v_pk_mul_f32 v[148:149], v[148:149], v[180:181]
    v_pk_mul_f32 v[150:151], v[150:151], v[182:183]
    v_cvt_pk_bf16_f32 v192, v136, v138
    v_cvt_pk_bf16_f32 v193, v140, v142
    v_cvt_pk_bf16_f32 v194, v144, v146
    v_cvt_pk_bf16_f32 v195, v148, v150
    buffer_store_dwordx4 v[192:195], v42, s[64:67], s86 offen offset:0 sc0 sc1
    v_cvt_pk_bf16_f32 v196, v137, v139
    v_cvt_pk_bf16_f32 v197, v141, v143
    v_cvt_pk_bf16_f32 v198, v145, v147
    v_cvt_pk_bf16_f32 v199, v149, v151
    buffer_store_dwordx4 v[196:199], v43, s[64:67], s86 offen offset:0 sc0 sc1
    v_mov_b32 v152, v48
    v_mov_b32 v153, v48
    v_mov_b32 v154, v49
    v_mov_b32 v155, v49
    v_mov_b32 v156, v46
    v_mov_b32 v157, v46
    v_mov_b32 v158, v47
    v_mov_b32 v159, v47
    s_waitcnt lgkmcnt(7)
    v_pk_mul_f32 v[56:57], v[56:57], v[200:201]
    v_pk_mul_f32 v[88:89], v[88:89], v[200:201]
    v_pk_mul_f32 v[58:59], v[58:59], v[202:203]
    v_pk_mul_f32 v[90:91], v[90:91], v[202:203]
    s_waitcnt lgkmcnt(6)
    v_pk_mul_f32 v[60:61], v[60:61], v[204:205]
    v_pk_mul_f32 v[92:93], v[92:93], v[204:205]
    v_pk_mul_f32 v[62:63], v[62:63], v[206:207]
    v_pk_mul_f32 v[94:95], v[94:95], v[206:207]
    s_waitcnt lgkmcnt(5)
    v_pk_mul_f32 v[64:65], v[64:65], v[208:209]
    v_pk_mul_f32 v[96:97], v[96:97], v[208:209]
    v_pk_mul_f32 v[66:67], v[66:67], v[210:211]
    v_pk_mul_f32 v[98:99], v[98:99], v[210:211]
    s_waitcnt lgkmcnt(4)
    v_pk_mul_f32 v[68:69], v[68:69], v[212:213]
    v_pk_mul_f32 v[100:101], v[100:101], v[212:213]
    v_pk_mul_f32 v[70:71], v[70:71], v[214:215]
    v_pk_mul_f32 v[102:103], v[102:103], v[214:215]
    v_pk_mul_f32 v[160:161], v[56:57], v[152:153]
    v_pk_mul_f32 v[164:165], v[56:57], v[154:155]
    v_pk_fma_f32 v[56:57], v[88:89], v[154:155], v[160:161]
    v_pk_fma_f32 v[88:89], v[88:89], v[152:153], v[164:165] neg_lo:[0,1,0] neg_hi:[0,1,0]
    v_pk_mul_f32 v[162:163], v[58:59], v[152:153]
    v_pk_mul_f32 v[166:167], v[58:59], v[154:155]
    v_pk_fma_f32 v[58:59], v[90:91], v[154:155], v[162:163]
    v_pk_fma_f32 v[90:91], v[90:91], v[152:153], v[166:167] neg_lo:[0,1,0] neg_hi:[0,1,0]
    v_pk_mul_f32 v[160:161], v[60:61], v[152:153]
    v_pk_mul_f32 v[164:165], v[60:61], v[154:155]
    v_pk_fma_f32 v[60:61], v[92:93], v[154:155], v[160:161]
    v_pk_fma_f32 v[92:93], v[92:93], v[152:153], v[164:165] neg_lo:[0,1,0] neg_hi:[0,1,0]
    v_pk_mul_f32 v[162:163], v[62:63], v[152:153]
    v_pk_mul_f32 v[166:167], v[62:63], v[154:155]
    v_pk_fma_f32 v[62:63], v[94:95], v[154:155], v[162:163]
    v_pk_fma_f32 v[94:95], v[94:95], v[152:153], v[166:167] neg_lo:[0,1,0] neg_hi:[0,1,0]
    v_pk_mul_f32 v[160:161], v[64:65], v[152:153]
    v_pk_mul_f32 v[164:165], v[64:65], v[154:155]
    v_pk_fma_f32 v[64:65], v[96:97], v[154:155], v[160:161]
    v_pk_fma_f32 v[96:97], v[96:97], v[152:153], v[164:165] neg_lo:[0,1,0] neg_hi:[0,1,0]
    v_pk_mul_f32 v[162:163], v[66:67], v[152:153]
    v_pk_mul_f32 v[166:167], v[66:67], v[154:155]
    v_pk_fma_f32 v[66:67], v[98:99], v[154:155], v[162:163]
    v_pk_fma_f32 v[98:99], v[98:99], v[152:153], v[166:167] neg_lo:[0,1,0] neg_hi:[0,1,0]
    v_pk_mul_f32 v[160:161], v[68:69], v[152:153]
    v_pk_mul_f32 v[164:165], v[68:69], v[154:155]
    v_pk_fma_f32 v[68:69], v[100:101], v[154:155], v[160:161]
    v_pk_fma_f32 v[100:101], v[100:101], v[152:153], v[164:165] neg_lo:[0,1,0] neg_hi:[0,1,0]
    v_pk_mul_f32 v[162:163], v[70:71], v[152:153]
    v_pk_mul_f32 v[166:167], v[70:71], v[154:155]
    v_pk_fma_f32 v[70:71], v[102:103], v[154:155], v[162:163]
    v_pk_fma_f32 v[102:103], v[102:103], v[152:153], v[166:167] neg_lo:[0,1,0] neg_hi:[0,1,0]
    s_waitcnt lgkmcnt(3)
    v_pk_mul_f32 v[72:73], v[72:73], v[216:217]
    v_pk_mul_f32 v[104:105], v[104:105], v[216:217]
    v_pk_mul_f32 v[74:75], v[74:75], v[218:219]
    v_pk_mul_f32 v[106:107], v[106:107], v[218:219]
    s_waitcnt lgkmcnt(2)
    v_pk_mul_f32 v[76:77], v[76:77], v[220:221]
    v_pk_mul_f32 v[108:109], v[108:109], v[220:221]
    v_pk_mul_f32 v[78:79], v[78:79], v[222:223]
    v_pk_mul_f32 v[110:111], v[110:111], v[222:223]
    s_waitcnt lgkmcnt(1)
    v_pk_mul_f32 v[80:81], v[80:81], v[224:225]
    v_pk_mul_f32 v[112:113], v[112:113], v[224:225]
    v_pk_mul_f32 v[82:83], v[82:83], v[226:227]
    v_pk_mul_f32 v[114:115], v[114:115], v[226:227]
    s_waitcnt lgkmcnt(0)
    v_pk_mul_f32 v[84:85], v[84:85], v[228:229]
    v_pk_mul_f32 v[116:117], v[116:117], v[228:229]
    v_pk_mul_f32 v[86:87], v[86:87], v[230:231]
    v_pk_mul_f32 v[118:119], v[118:119], v[230:231]
    v_pk_mul_f32 v[160:161], v[72:73], v[152:153]
    v_pk_mul_f32 v[164:165], v[72:73], v[154:155]
    v_pk_fma_f32 v[72:73], v[104:105], v[154:155], v[160:161]
    v_pk_fma_f32 v[104:105], v[104:105], v[152:153], v[164:165] neg_lo:[0,1,0] neg_hi:[0,1,0]
    v_pk_mul_f32 v[162:163], v[74:75], v[152:153]
    v_pk_mul_f32 v[166:167], v[74:75], v[154:155]
    v_pk_fma_f32 v[74:75], v[106:107], v[154:155], v[162:163]
    v_pk_fma_f32 v[106:107], v[106:107], v[152:153], v[166:167] neg_lo:[0,1,0] neg_hi:[0,1,0]
    v_pk_mul_f32 v[160:161], v[76:77], v[152:153]
    v_pk_mul_f32 v[164:165], v[76:77], v[154:155]
    v_pk_fma_f32 v[76:77], v[108:109], v[154:155], v[160:161]
    v_pk_fma_f32 v[108:109], v[108:109], v[152:153], v[164:165] neg_lo:[0,1,0] neg_hi:[0,1,0]
    v_pk_mul_f32 v[162:163], v[78:79], v[152:153]
    v_pk_mul_f32 v[166:167], v[78:79], v[154:155]
    v_pk_fma_f32 v[78:79], v[110:111], v[154:155], v[162:163]
    v_pk_fma_f32 v[110:111], v[110:111], v[152:153], v[166:167] neg_lo:[0,1,0] neg_hi:[0,1,0]
    v_pk_mul_f32 v[160:161], v[80:81], v[152:153]
    v_pk_mul_f32 v[164:165], v[80:81], v[154:155]
    v_pk_fma_f32 v[80:81], v[112:113], v[154:155], v[160:161]
    v_pk_fma_f32 v[112:113], v[112:113], v[152:153], v[164:165] neg_lo:[0,1,0] neg_hi:[0,1,0]
    v_pk_mul_f32 v[162:163], v[82:83], v[152:153]
    v_pk_mul_f32 v[166:167], v[82:83], v[154:155]
    v_pk_fma_f32 v[82:83], v[114:115], v[154:155], v[162:163]
    v_pk_fma_f32 v[114:115], v[114:115], v[152:153], v[166:167] neg_lo:[0,1,0] neg_hi:[0,1,0]
    v_pk_mul_f32 v[160:161], v[84:85], v[152:153]
    v_pk_mul_f32 v[164:165], v[84:85], v[154:155]
    v_pk_fma_f32 v[84:85], v[116:117], v[154:155], v[160:161]
    v_pk_fma_f32 v[116:117], v[116:117], v[152:153], v[164:165] neg_lo:[0,1,0] neg_hi:[0,1,0]
    v_pk_mul_f32 v[162:163], v[86:87], v[152:153]
    v_pk_mul_f32 v[166:167], v[86:87], v[154:155]
    v_pk_fma_f32 v[86:87], v[118:119], v[154:155], v[162:163]
    v_pk_fma_f32 v[118:119], v[118:119], v[152:153], v[166:167] neg_lo:[0,1,0] neg_hi:[0,1,0]
    v_pk_fma_f32 v[58:59], v[56:57], v[156:157], v[58:59]
    v_pk_fma_f32 v[90:91], v[88:89], v[156:157], v[90:91]
    v_pk_fma_f32 v[74:75], v[72:73], v[156:157], v[74:75]
    v_pk_fma_f32 v[106:107], v[104:105], v[156:157], v[106:107]
    v_pk_fma_f32 v[58:59], v[88:89], v[158:159], v[58:59] neg_lo:[0,1,0] neg_hi:[0,1,0]
    v_pk_fma_f32 v[90:91], v[56:57], v[158:159], v[90:91]
    v_pk_fma_f32 v[74:75], v[104:105], v[158:159], v[74:75] neg_lo:[0,1,0] neg_hi:[0,1,0]
    v_pk_fma_f32 v[106:107], v[72:73], v[158:159], v[106:107]
    v_pk_fma_f32 v[60:61], v[58:59], v[156:157], v[60:61]
    v_pk_fma_f32 v[92:93], v[90:91], v[156:157], v[92:93]
    v_pk_fma_f32 v[76:77], v[74:75], v[156:157], v[76:77]
    v_pk_fma_f32 v[108:109], v[106:107], v[156:157], v[108:109]
    v_pk_fma_f32 v[60:61], v[90:91], v[158:159], v[60:61] neg_lo:[0,1,0] neg_hi:[0,1,0]
    v_pk_fma_f32 v[92:93], v[58:59], v[158:159], v[92:93]
    v_pk_fma_f32 v[76:77], v[106:107], v[158:159], v[76:77] neg_lo:[0,1,0] neg_hi:[0,1,0]
    v_pk_fma_f32 v[108:109], v[74:75], v[158:159], v[108:109]
    v_pk_fma_f32 v[62:63], v[60:61], v[156:157], v[62:63]
    v_pk_fma_f32 v[94:95], v[92:93], v[156:157], v[94:95]
    v_pk_fma_f32 v[78:79], v[76:77], v[156:157], v[78:79]
    v_pk_fma_f32 v[110:111], v[108:109], v[156:157], v[110:111]
    v_pk_fma_f32 v[62:63], v[92:93], v[158:159], v[62:63] neg_lo:[0,1,0] neg_hi:[0,1,0]
    v_pk_fma_f32 v[94:95], v[60:61], v[158:159], v[94:95]
    v_pk_fma_f32 v[78:79], v[108:109], v[158:159], v[78:79] neg_lo:[0,1,0] neg_hi:[0,1,0]
    v_pk_fma_f32 v[110:111], v[76:77], v[158:159], v[110:111]
    v_pk_fma_f32 v[64:65], v[62:63], v[156:157], v[64:65]
    v_pk_fma_f32 v[96:97], v[94:95], v[156:157], v[96:97]
    v_pk_fma_f32 v[80:81], v[78:79], v[156:157], v[80:81]
    v_pk_fma_f32 v[112:113], v[110:111], v[156:157], v[112:113]
    v_pk_fma_f32 v[64:65], v[94:95], v[158:159], v[64:65] neg_lo:[0,1,0] neg_hi:[0,1,0]
    v_pk_fma_f32 v[96:97], v[62:63], v[158:159], v[96:97]
    v_pk_fma_f32 v[80:81], v[110:111], v[158:159], v[80:81] neg_lo:[0,1,0] neg_hi:[0,1,0]
    v_pk_fma_f32 v[112:113], v[78:79], v[158:159], v[112:113]
    v_pk_fma_f32 v[66:67], v[64:65], v[156:157], v[66:67]
    v_pk_fma_f32 v[98:99], v[96:97], v[156:157], v[98:99]
    v_pk_fma_f32 v[82:83], v[80:81], v[156:157], v[82:83]
    v_pk_fma_f32 v[114:115], v[112:113], v[156:157], v[114:115]
    v_pk_fma_f32 v[66:67], v[96:97], v[158:159], v[66:67] neg_lo:[0,1,0] neg_hi:[0,1,0]
    v_pk_fma_f32 v[98:99], v[64:65], v[158:159], v[98:99]
    v_pk_fma_f32 v[82:83], v[112:113], v[158:159], v[82:83] neg_lo:[0,1,0] neg_hi:[0,1,0]
    v_pk_fma_f32 v[114:115], v[80:81], v[158:159], v[114:115]
    v_pk_fma_f32 v[68:69], v[66:67], v[156:157], v[68:69]
    v_pk_fma_f32 v[100:101], v[98:99], v[156:157], v[100:101]
    v_pk_fma_f32 v[84:85], v[82:83], v[156:157], v[84:85]
    v_pk_fma_f32 v[116:117], v[114:115], v[156:157], v[116:117]
    v_pk_fma_f32 v[68:69], v[98:99], v[158:159], v[68:69] neg_lo:[0,1,0] neg_hi:[0,1,0]
    v_pk_fma_f32 v[100:101], v[66:67], v[158:159], v[100:101]
    v_pk_fma_f32 v[84:85], v[114:115], v[158:159], v[84:85] neg_lo:[0,1,0] neg_hi:[0,1,0]
    v_pk_fma_f32 v[116:117], v[82:83], v[158:159], v[116:117]
    v_pk_fma_f32 v[70:71], v[68:69], v[156:157], v[70:71]
    v_pk_fma_f32 v[102:103], v[100:101], v[156:157], v[102:103]
    v_pk_fma_f32 v[86:87], v[84:85], v[156:157], v[86:87]
    v_pk_fma_f32 v[118:119], v[116:117], v[156:157], v[118:119]
    v_pk_fma_f32 v[70:71], v[100:101], v[158:159], v[70:71] neg_lo:[0,1,0] neg_hi:[0,1,0]
    v_pk_fma_f32 v[102:103], v[68:69], v[158:159], v[102:103]
    v_pk_fma_f32 v[86:87], v[116:117], v[158:159], v[86:87] neg_lo:[0,1,0] neg_hi:[0,1,0]
    v_pk_fma_f32 v[118:119], v[84:85], v[158:159], v[118:119]
    v_fma_f32 v168, v246, v70, v71
    v_fma_f32 v169, v246, v102, v103
    v_fma_f32 v168, -v247, v102, v168
    v_fma_f32 v169, v247, v70, v169
    v_mul_f32 v174, v246, v246
    v_mul_f32 v175, v246, v247
    v_fma_f32 v174, -v247, v247, v174
    v_fma_f32 v175, v247, v246, v175
    v_fma_f32 v170, v246, v168, v86
    v_fma_f32 v171, v246, v169, v118
    v_fma_f32 v170, -v247, v169, v170
    v_fma_f32 v171, v247, v168, v171
    v_mul_f32 v176, v174, v174
    v_mul_f32 v177, v174, v175
    v_fma_f32 v176, -v175, v175, v176
    v_fma_f32 v177, v175, v174, v177
    v_fma_f32 v172, v246, v170, v87
    v_fma_f32 v173, v246, v171, v119
    v_fma_f32 v172, -v247, v171, v172
    v_fma_f32 v173, v247, v170, v173
    v_mul_f32 v178, v176, v176
    v_mul_f32 v179, v176, v177
    v_fma_f32 v178, -v177, v177, v178
    v_fma_f32 v179, v177, v176, v179
    v_mov_b32 v180, v172
    v_mov_b32 v181, v173
    s_nop 0
    v_permlane32_swap_b32 v172, v180
    v_permlane32_swap_b32 v173, v181
    v_fma_f32 v160, v176, v172, v180
    v_fma_f32 v161, v176, v173, v181
    v_fma_f32 v160, -v177, v173, v160
    v_fma_f32 v161, v177, v172, v161
    v_mov_b32 v162, s46
    v_mov_b32 v163, s47
    s_lshl_b32 s79, s75, 5
    s_add_u32 s79, s79, s93
    s_lshl_b32 s79, s79, 9
    s_add_u32 s85, s79, 11075584
    s_mov_b32 exec_hi, 0
    buffer_store_dwordx4 v[160:163], v5, s[64:67], s85 offen sc0 sc1
    s_lshr_b32 s79, s79, 6
    s_add_u32 s79, s79, 11370496
    s_mov_b64 exec, 1
    buffer_store_dwordx2 v[162:163], v4, s[64:67], s79 offen sc0 sc1
    s_mov_b64 exec, -1
    s_waitcnt vmcnt(2)
    s_lshl_b32 s79, s92, 4
    s_add_u32 s79, s79, 11337728
    v_mov_b32 v8, s46
    v_mov_b32 v9, s47
    s_mov_b64 exec, 1
    buffer_store_dwordx2 v[8:9], v4, s[64:67], s79 offen sc0 sc1
    s_mov_b64 exec, -1
    v_sub_u32 v29, 2, v2
    v_add_u32 v28, s85, v5
    v_cmp_gt_u32 s[10:11], s93, v1
    s_lshl_b32 s79, s75, 8
    s_add_u32 s79, s79, 11370496
    v_and_b32 v9, 31, v1
    v_lshl_add_u32 v36, v9, 3, s79
L_eh_retry:
    s_add_u32 s3, s3, 1
    s_cmp_gt_u32 s3, 1048576
    s_cbranch_scc1 L_eh_ok
    s_sleep 1
    buffer_load_dwordx2 v[44:45], v36, s[64:67], 0 offen sc0 sc1
    s_waitcnt vmcnt(0)
    v_cmp_ne_u64 vcc, s[46:47], v[44:45]
    s_nop 1
    s_and_b64 vcc, vcc, s[10:11]
    s_cmp_eq_u64 vcc, 0
    s_cbranch_scc0 L_eh_retry
L_eh_ok:
L_eg_retry:
    s_add_u32 s3, s3, 1
    s_cmp_gt_u32 s3, 1048576
    s_cbranch_scc1 L_eg_ok
    v_add_u32 v8, 0, v29
    v_cmp_ge_u32 vcc, s93, v8
    v_subrev_u32 v9, 1024, v28
    v_mov_b32 v10, 1073741824
    v_cndmask_b32 v32, v10, v9, vcc
    buffer_load_dwordx4 v[120:123], v32, s[64:67], 0 offen sc0 sc1
    v_add_u32 v8, 2, v29
    v_cmp_ge_u32 vcc, s93, v8
    v_subrev_u32 v9, 2048, v28
    v_mov_b32 v10, 1073741824
    v_cndmask_b32 v33, v10, v9, vcc
    buffer_load_dwordx4 v[124:127], v33, s[64:67], 0 offen sc0 sc1
    v_add_u32 v8, 4, v29
    v_cmp_ge_u32 vcc, s93, v8
    v_subrev_u32 v9, 3072, v28
    v_mov_b32 v10, 1073741824
    v_cndmask_b32 v34, v10, v9, vcc
    buffer_load_dwordx4 v[128:131], v34, s[64:67], 0 offen sc0 sc1
    v_add_u32 v8, 6, v29
    v_cmp_ge_u32 vcc, s93, v8
    v_subrev_u32 v9, 4096, v28
    v_mov_b32 v10, 1073741824
    v_cndmask_b32 v35, v10, v9, vcc
    buffer_load_dwordx4 v[132:135], v35, s[64:67], 0 offen sc0 sc1
    v_add_u32 v8, 8, v29
    v_cmp_ge_u32 vcc, s93, v8
    v_subrev_u32 v9, 5120, v28
    v_mov_b32 v10, 1073741824
    v_cndmask_b32 v32, v10, v9, vcc
    buffer_load_dwordx4 v[136:139], v32, s[64:67], 0 offen sc0 sc1
    v_add_u32 v8, 10, v29
    v_cmp_ge_u32 vcc, s93, v8
    v_subrev_u32 v9, 6144, v28
    v_mov_b32 v10, 1073741824
    v_cndmask_b32 v33, v10, v9, vcc
    buffer_load_dwordx4 v[140:143], v33, s[64:67], 0 offen sc0 sc1
    v_add_u32 v8, 12, v29
    v_cmp_ge_u32 vcc, s93, v8
    v_subrev_u32 v9, 7168, v28
    v_mov_b32 v10, 1073741824
    v_cndmask_b32 v34, v10, v9, vcc
    buffer_load_dwordx4 v[144:147], v34, s[64:67], 0 offen sc0 sc1
    v_add_u32 v8, 14, v29
    v_cmp_ge_u32 vcc, s93, v8
    v_subrev_u32 v9, 8192, v28
    v_mov_b32 v10, 1073741824
    v_cndmask_b32 v35, v10, v9, vcc
    buffer_load_dwordx4 v[148:151], v35, s[64:67], 0 offen sc0 sc1
    v_add_u32 v8, 16, v29
    v_cmp_ge_u32 vcc, s93, v8
    v_subrev_u32 v9, 9216, v28
    v_mov_b32 v10, 1073741824
    v_cndmask_b32 v32, v10, v9, vcc
    buffer_load_dwordx4 v[200:203], v32, s[64:67], 0 offen sc0 sc1
    v_add_u32 v8, 18, v29
    v_cmp_ge_u32 vcc, s93, v8
    v_subrev_u32 v9, 10240, v28
    v_mov_b32 v10, 1073741824
    v_cndmask_b32 v33, v10, v9, vcc
    buffer_load_dwordx4 v[204:207], v33, s[64:67], 0 offen sc0 sc1
    v_add_u32 v8, 20, v29
    v_cmp_ge_u32 vcc, s93, v8
    v_subrev_u32 v9, 11264, v28
    v_mov_b32 v10, 1073741824
    v_cndmask_b32 v34, v10, v9, vcc
    buffer_load_dwordx4 v[208:211], v34, s[64:67], 0 offen sc0 sc1
    v_add_u32 v8, 22, v29
    v_cmp_ge_u32 vcc, s93, v8
    v_subrev_u32 v9, 12288, v28
    v_mov_b32 v10, 1073741824
    v_cndmask_b32 v35, v10, v9, vcc
    buffer_load_dwordx4 v[212:215], v35, s[64:67], 0 offen sc0 sc1
    v_add_u32 v8, 24, v29
    v_cmp_ge_u32 vcc, s93, v8
    v_subrev_u32 v9, 13312, v28
    v_mov_b32 v10, 1073741824
    v_cndmask_b32 v32, v10, v9, vcc
    buffer_load_dwordx4 v[216:219], v32, s[64:67], 0 offen sc0 sc1
    v_add_u32 v8, 26, v29
    v_cmp_ge_u32 vcc, s93, v8
    v_subrev_u32 v9, 14336, v28
    v_mov_b32 v10, 1073741824
    v_cndmask_b32 v33, v10, v9, vcc
    buffer_load_dwordx4 v[220:223], v33, s[64:67], 0 offen sc0 sc1
    v_add_u32 v8, 28, v29
    v_cmp_ge_u32 vcc, s93, v8
    v_subrev_u32 v9, 15360, v28
    v_mov_b32 v10, 1073741824
    v_cndmask_b32 v34, v10, v9, vcc
    buffer_load_dwordx4 v[224:227], v34, s[64:67], 0 offen sc0 sc1
    v_add_u32 v8, 30, v29
    v_cmp_ge_u32 vcc, s93, v8
    v_subrev_u32 v9, 16384, v28
    v_mov_b32 v10, 1073741824
    v_cndmask_b32 v35, v10, v9, vcc
    buffer_load_dwordx4 v[228:231], v35, s[64:67], 0 offen sc0 sc1
    v_mul_f32 v182, v178, v178
    v_mul_f32 v183, v178, v179
    v_fma_f32 v182, -v179, v179, v182
    v_fma_f32 v183, v179, v178, v183
    v_add_u32 v8, 0, v29
    v_cmp_ge_u32 s[8:9], s93, v8
    s_waitcnt vmcnt(15)
    v_cmp_ne_u64 vcc, s[46:47], v[122:123]
    s_nop 0
    s_and_b64 vcc, vcc, s[8:9]
    s_mov_b64 s[4:5], vcc
    v_add_u32 v8, 2, v29
    v_cmp_ge_u32 s[8:9], s93, v8
    s_waitcnt vmcnt(14)
    v_cmp_ne_u64 vcc, s[46:47], v[126:127]
    s_nop 0
    s_and_b64 vcc, vcc, s[8:9]
    s_or_b64 s[4:5], s[4:5], vcc
    v_add_u32 v8, 4, v29
    v_cmp_ge_u32 s[8:9], s93, v8
    s_waitcnt vmcnt(13)
    v_cmp_ne_u64 vcc, s[46:47], v[130:131]
    s_nop 0
    s_and_b64 vcc, vcc, s[8:9]
    s_or_b64 s[4:5], s[4:5], vcc
    v_add_u32 v8, 6, v29
    v_cmp_ge_u32 s[8:9], s93, v8
    s_waitcnt vmcnt(12)
    v_cmp_ne_u64 vcc, s[46:47], v[134:135]
    s_nop 0
    s_and_b64 vcc, vcc, s[8:9]
    s_or_b64 s[4:5], s[4:5], vcc
    v_add_u32 v8, 8, v29
    v_cmp_ge_u32 s[8:9], s93, v8
    s_waitcnt vmcnt(11)
    v_cmp_ne_u64 vcc, s[46:47], v[138:139]
    s_nop 0
    s_and_b64 vcc, vcc, s[8:9]
    s_or_b64 s[4:5], s[4:5], vcc
    v_add_u32 v8, 10, v29
    v_cmp_ge_u32 s[8:9], s93, v8
    s_waitcnt vmcnt(10)
    v_cmp_ne_u64 vcc, s[46:47], v[142:143]
    s_nop 0
    s_and_b64 vcc, vcc, s[8:9]
    s_or_b64 s[4:5], s[4:5], vcc
    v_add_u32 v8, 12, v29
    v_cmp_ge_u32 s[8:9], s93, v8
    s_waitcnt vmcnt(9)
    v_cmp_ne_u64 vcc, s[46:47], v[146:147]
    s_nop 0
    s_and_b64 vcc, vcc, s[8:9]
    s_or_b64 s[4:5], s[4:5], vcc
    v_add_u32 v8, 14, v29
    v_cmp_ge_u32 s[8:9], s93, v8
    s_waitcnt vmcnt(8)
    v_cmp_ne_u64 vcc, s[46:47], v[150:151]
    s_nop 0
    s_and_b64 vcc, vcc, s[8:9]
    s_or_b64 s[4:5], s[4:5], vcc
    v_add_u32 v8, 16, v29
    v_cmp_ge_u32 s[8:9], s93, v8
    s_waitcnt vmcnt(7)
    v_cmp_ne_u64 vcc, s[46:47], v[202:203]
    s_nop 0
    s_and_b64 vcc, vcc, s[8:9]
    s_or_b64 s[4:5], s[4:5], vcc
    v_add_u32 v8, 18, v29
    v_cmp_ge_u32 s[8:9], s93, v8
    s_waitcnt vmcnt(6)
    v_cmp_ne_u64 vcc, s[46:47], v[206:207]
    s_nop 0
    s_and_b64 vcc, vcc, s[8:9]
    s_or_b64 s[4:5], s[4:5], vcc
    v_add_u32 v8, 20, v29
    v_cmp_ge_u32 s[8:9], s93, v8
    s_waitcnt vmcnt(5)
    v_cmp_ne_u64 vcc, s[46:47], v[210:211]
    s_nop 0
    s_and_b64 vcc, vcc, s[8:9]
    s_or_b64 s[4:5], s[4:5], vcc
    v_add_u32 v8, 22, v29
    v_cmp_ge_u32 s[8:9], s93, v8
    s_waitcnt vmcnt(4)
    v_cmp_ne_u64 vcc, s[46:47], v[214:215]
    s_nop 0
    s_and_b64 vcc, vcc, s[8:9]
    s_or_b64 s[4:5], s[4:5], vcc
    v_add_u32 v8, 24, v29
    v_cmp_ge_u32 s[8:9], s93, v8
    s_waitcnt vmcnt(3)
    v_cmp_ne_u64 vcc, s[46:47], v[218:219]
    s_nop 0
    s_and_b64 vcc, vcc, s[8:9]
    s_or_b64 s[4:5], s[4:5], vcc
    v_add_u32 v8, 26, v29
    v_cmp_ge_u32 s[8:9], s93, v8
    s_waitcnt vmcnt(2)
    v_cmp_ne_u64 vcc, s[46:47], v[222:223]
    s_nop 0
    s_and_b64 vcc, vcc, s[8:9]
    s_or_b64 s[4:5], s[4:5], vcc
    v_add_u32 v8, 28, v29
    v_cmp_ge_u32 s[8:9], s93, v8
    s_waitcnt vmcnt(1)
    v_cmp_ne_u64 vcc, s[46:47], v[226:227]
    s_nop 0
    s_and_b64 vcc, vcc, s[8:9]
    s_or_b64 s[4:5], s[4:5], vcc
    v_add_u32 v8, 30, v29
    v_cmp_ge_u32 s[8:9], s93, v8
    s_waitcnt vmcnt(0)
    v_cmp_ne_u64 vcc, s[46:47], v[230:231]
    s_nop 0
    s_and_b64 vcc, vcc, s[8:9]
    s_or_b64 s[4:5], s[4:5], vcc
    s_cmp_eq_u64 s[4:5], 0
    s_cbranch_scc0 L_eg_retry
L_eg_ok:
    v_fma_f32 v160, v182, v228, v224
    v_fma_f32 v161, v182, v229, v225
    v_fma_f32 v160, -v183, v229, v160
    v_fma_f32 v161, v183, v228, v161
    v_fma_f32 v162, v182, v160, v220
    v_fma_f32 v163, v182, v161, v221
    v_fma_f32 v162, -v183, v161, v162
    v_fma_f32 v163, v183, v160, v163
    v_fma_f32 v160, v182, v162, v216
    v_fma_f32 v161, v182, v163, v217
    v_fma_f32 v160, -v183, v163, v160
    v_fma_f32 v161, v183, v162, v161
    v_fma_f32 v162, v182, v160, v212
    v_fma_f32 v163, v182, v161, v213
    v_fma_f32 v162, -v183, v161, v162
    v_fma_f32 v163, v183, v160, v163
    v_fma_f32 v160, v182, v162, v208
    v_fma_f32 v161, v182, v163, v209
    v_fma_f32 v160, -v183, v163, v160
    v_fma_f32 v161, v183, v162, v161
    v_fma_f32 v162, v182, v160, v204
    v_fma_f32 v163, v182, v161, v205
    v_fma_f32 v162, -v183, v161, v162
    v_fma_f32 v163, v183, v160, v163
    v_fma_f32 v160, v182, v162, v200
    v_fma_f32 v161, v182, v163, v201
    v_fma_f32 v160, -v183, v163, v160
    v_fma_f32 v161, v183, v162, v161
    v_fma_f32 v162, v182, v160, v148
    v_fma_f32 v163, v182, v161, v149
    v_fma_f32 v162, -v183, v161, v162
    v_fma_f32 v163, v183, v160, v163
    v_fma_f32 v160, v182, v162, v144
    v_fma_f32 v161, v182, v163, v145
    v_fma_f32 v160, -v183, v163, v160
    v_fma_f32 v161, v183, v162, v161
    v_fma_f32 v162, v182, v160, v140
    v_fma_f32 v163, v182, v161, v141
    v_fma_f32 v162, -v183, v161, v162
    v_fma_f32 v163, v183, v160, v163
    v_fma_f32 v160, v182, v162, v136
    v_fma_f32 v161, v182, v163, v137
    v_fma_f32 v160, -v183, v163, v160
    v_fma_f32 v161, v183, v162, v161
    v_fma_f32 v162, v182, v160, v132
    v_fma_f32 v163, v182, v161, v133
    v_fma_f32 v162, -v183, v161, v162
    v_fma_f32 v163, v183, v160, v163
    v_fma_f32 v160, v182, v162, v128
    v_fma_f32 v161, v182, v163, v129
    v_fma_f32 v160, -v183, v163, v160
    v_fma_f32 v161, v183, v162, v161
    v_fma_f32 v162, v182, v160, v124
    v_fma_f32 v163, v182, v161, v125
    v_fma_f32 v162, -v183, v161, v162
    v_fma_f32 v163, v183, v160, v163
    v_fma_f32 v160, v182, v162, v120
    v_fma_f32 v161, v182, v163, v121
    v_fma_f32 v160, -v183, v163, v160
    v_fma_f32 v161, v183, v162, v161
    v_mul_f32 v162, v160, v178
    v_mul_f32 v163, v160, v179
    v_fma_f32 v162, -v161, v179, v162
    v_fma_f32 v163, v161, v178, v163
    v_cmp_eq_u32 vcc, 0, v2
    s_nop 1
    v_cndmask_b32 v160, v160, v162, vcc
    v_cndmask_b32 v161, v161, v163, vcc
    v_mov_b32 v162, v160
    v_mov_b32 v163, v161
    s_nop 0
    v_permlane32_swap_b32 v160, v162
    v_permlane32_swap_b32 v161, v163
    v_add_f32 v160, v160, v162
    v_add_f32 v161, v161, v163
    v_fma_f32 v162, v176, v160, v172
    v_fma_f32 v163, v176, v161, v173
    v_fma_f32 v162, -v177, v161, v162
    v_fma_f32 v163, v177, v160, v163
    v_cndmask_b32 v164, v162, v160, vcc
    v_cndmask_b32 v166, v163, v161, vcc
    v_fma_f32 v165, v246, v164, v70
    v_fma_f32 v167, v246, v166, v102
    v_fma_f32 v165, -v247, v166, v165
    v_fma_f32 v167, v247, v164, v167
    v_fma_f32 v188, v246, v165, v71
    v_fma_f32 v190, v246, v167, v103
    v_fma_f32 v188, -v247, v167, v188
    v_fma_f32 v190, v247, v165, v190
    v_fma_f32 v189, v246, v188, v86
    v_fma_f32 v191, v246, v190, v118
    v_fma_f32 v189, -v247, v190, v189
    v_fma_f32 v191, v247, v188, v191
    v_mov_b32 v120, v232
    v_mov_b32 v121, v232
    v_mov_b32 v122, v233
    v_mov_b32 v123, v233
    v_pk_fma_f32 v[56:57], v[164:165], v[120:121], v[56:57]
    v_pk_fma_f32 v[88:89], v[166:167], v[120:121], v[88:89]
    v_pk_fma_f32 v[72:73], v[188:189], v[120:121], v[72:73]
    v_pk_fma_f32 v[104:105], v[190:191], v[120:121], v[104:105]
    v_pk_fma_f32 v[56:57], v[166:167], v[122:123], v[56:57] neg_lo:[0,1,0] neg_hi:[0,1,0]
    v_pk_fma_f32 v[88:89], v[164:165], v[122:123], v[88:89]
    v_pk_fma_f32 v[72:73], v[190:191], v[122:123], v[72:73] neg_lo:[0,1,0] neg_hi:[0,1,0]
    v_pk_fma_f32 v[104:105], v[188:189], v[122:123], v[104:105]
    v_mov_b32 v124, v234
    v_mov_b32 v125, v234
    v_mov_b32 v126, v235
    v_mov_b32 v127, v235
    v_pk_fma_f32 v[58:59], v[164:165], v[124:125], v[58:59]
    v_pk_fma_f32 v[90:91], v[166:167], v[124:125], v[90:91]
    v_pk_fma_f32 v[74:75], v[188:189], v[124:125], v[74:75]
    v_pk_fma_f32 v[106:107], v[190:191], v[124:125], v[106:107]
    v_pk_fma_f32 v[58:59], v[166:167], v[126:127], v[58:59] neg_lo:[0,1,0] neg_hi:[0,1,0]
    v_pk_fma_f32 v[90:91], v[164:165], v[126:127], v[90:91]
    v_pk_fma_f32 v[74:75], v[190:191], v[126:127], v[74:75] neg_lo:[0,1,0] neg_hi:[0,1,0]
    v_pk_fma_f32 v[106:107], v[188:189], v[126:127], v[106:107]
    v_mov_b32 v128, v236
    v_mov_b32 v129, v236
    v_mov_b32 v130, v237
    v_mov_b32 v131, v237
    v_pk_fma_f32 v[60:61], v[164:165], v[128:129], v[60:61]
    v_pk_fma_f32 v[92:93], v[166:167], v[128:129], v[92:93]
    v_pk_fma_f32 v[76:77], v[188:189], v[128:129], v[76:77]
    v_pk_fma_f32 v[108:109], v[190:191], v[128:129], v[108:109]
    v_pk_fma_f32 v[60:61], v[166:167], v[130:131], v[60:61] neg_lo:[0,1,0] neg_hi:[0,1,0]
    v_pk_fma_f32 v[92:93], v[164:165], v[130:131], v[92:93]
    v_pk_fma_f32 v[76:77], v[190:191], v[130:131], v[76:77] neg_lo:[0,1,0] neg_hi:[0,1,0]
    v_pk_fma_f32 v[108:109], v[188:189], v[130:131], v[108:109]
    v_mov_b32 v132, v238
    v_mov_b32 v133, v238
    v_mov_b32 v134, v239
    v_mov_b32 v135, v239
    v_pk_fma_f32 v[62:63], v[164:165], v[132:133], v[62:63]
    v_pk_fma_f32 v[94:95], v[166:167], v[132:133], v[94:95]
    v_pk_fma_f32 v[78:79], v[188:189], v[132:133], v[78:79]
    v_pk_fma_f32 v[110:111], v[190:191], v[132:133], v[110:111]
    v_pk_fma_f32 v[62:63], v[166:167], v[134:135], v[62:63] neg_lo:[0,1,0] neg_hi:[0,1,0]
    v_pk_fma_f32 v[94:95], v[164:165], v[134:135], v[94:95]
    v_pk_fma_f32 v[78:79], v[190:191], v[134:135], v[78:79] neg_lo:[0,1,0] neg_hi:[0,1,0]
    v_pk_fma_f32 v[110:111], v[188:189], v[134:135], v[110:111]
    v_mov_b32 v120, v240
    v_mov_b32 v121, v240
    v_mov_b32 v122, v241
    v_mov_b32 v123, v241
    v_pk_fma_f32 v[64:65], v[164:165], v[120:121], v[64:65]
    v_pk_fma_f32 v[96:97], v[166:167], v[120:121], v[96:97]
    v_pk_fma_f32 v[80:81], v[188:189], v[120:121], v[80:81]
    v_pk_fma_f32 v[112:113], v[190:191], v[120:121], v[112:113]
    v_pk_fma_f32 v[64:65], v[166:167], v[122:123], v[64:65] neg_lo:[0,1,0] neg_hi:[0,1,0]
    v_pk_fma_f32 v[96:97], v[164:165], v[122:123], v[96:97]
    v_pk_fma_f32 v[80:81], v[190:191], v[122:123], v[80:81] neg_lo:[0,1,0] neg_hi:[0,1,0]
    v_pk_fma_f32 v[112:113], v[188:189], v[122:123], v[112:113]
    v_mov_b32 v124, v242
    v_mov_b32 v125, v242
    v_mov_b32 v126, v243
    v_mov_b32 v127, v243
    v_pk_fma_f32 v[66:67], v[164:165], v[124:125], v[66:67]
    v_pk_fma_f32 v[98:99], v[166:167], v[124:125], v[98:99]
    v_pk_fma_f32 v[82:83], v[188:189], v[124:125], v[82:83]
    v_pk_fma_f32 v[114:115], v[190:191], v[124:125], v[114:115]
    v_pk_fma_f32 v[66:67], v[166:167], v[126:127], v[66:67] neg_lo:[0,1,0] neg_hi:[0,1,0]
    v_pk_fma_f32 v[98:99], v[164:165], v[126:127], v[98:99]
    v_pk_fma_f32 v[82:83], v[190:191], v[126:127], v[82:83] neg_lo:[0,1,0] neg_hi:[0,1,0]
    v_pk_fma_f32 v[114:115], v[188:189], v[126:127], v[114:115]
    v_mov_b32 v128, v244
    v_mov_b32 v129, v244
    v_mov_b32 v130, v245
    v_mov_b32 v131, v245
    v_pk_fma_f32 v[68:69], v[164:165], v[128:129], v[68:69]
    v_pk_fma_f32 v[100:101], v[166:167], v[128:129], v[100:101]
    v_pk_fma_f32 v[84:85], v[188:189], v[128:129], v[84:85]
    v_pk_fma_f32 v[116:117], v[190:191], v[128:129], v[116:117]
    v_pk_fma_f32 v[68:69], v[166:167], v[130:131], v[68:69] neg_lo:[0,1,0] neg_hi:[0,1,0]
    v_pk_fma_f32 v[100:101], v[164:165], v[130:131], v[100:101]
    v_pk_fma_f32 v[84:85], v[190:191], v[130:131], v[84:85] neg_lo:[0,1,0] neg_hi:[0,1,0]
    v_pk_fma_f32 v[116:117], v[188:189], v[130:131], v[116:117]
    v_mov_b32 v132, v246
    v_mov_b32 v133, v246
    v_mov_b32 v134, v247
    v_mov_b32 v135, v247
    v_pk_fma_f32 v[70:71], v[164:165], v[132:133], v[70:71]
    v_pk_fma_f32 v[102:103], v[166:167], v[132:133], v[102:103]
    v_pk_fma_f32 v[86:87], v[188:189], v[132:133], v[86:87]
    v_pk_fma_f32 v[118:119], v[190:191], v[132:133], v[118:119]
    v_pk_fma_f32 v[70:71], v[166:167], v[134:135], v[70:71] neg_lo:[0,1,0] neg_hi:[0,1,0]
    v_pk_fma_f32 v[102:103], v[164:165], v[134:135], v[102:103]
    v_pk_fma_f32 v[86:87], v[190:191], v[134:135], v[86:87] neg_lo:[0,1,0] neg_hi:[0,1,0]
    v_pk_fma_f32 v[118:119], v[188:189], v[134:135], v[118:119]
    v_cvt_pk_bf16_f32 v200, v56, v58
    v_cvt_pk_bf16_f32 v201, v60, v62
    v_cvt_pk_bf16_f32 v202, v64, v66
    v_cvt_pk_bf16_f32 v203, v68, v70
    buffer_store_dwordx4 v[200:203], v40, s[64:67], s87 offen offset:0 sc0 sc1
    v_cvt_pk_bf16_f32 v204, v57, v59
    v_cvt_pk_bf16_f32 v205, v61, v63
    v_cvt_pk_bf16_f32 v206, v65, v67
    v_cvt_pk_bf16_f32 v207, v69, v71
    buffer_store_dwordx4 v[204:207], v41, s[64:67], s87 offen offset:0 sc0 sc1
    v_cvt_pk_bf16_f32 v208, v88, v90
    v_cvt_pk_bf16_f32 v209, v92, v94
    v_cvt_pk_bf16_f32 v210, v96, v98
    v_cvt_pk_bf16_f32 v211, v100, v102
    buffer_store_dwordx4 v[208:211], v40, s[64:67], s87 offen offset:2048 sc0 sc1
    v_cvt_pk_bf16_f32 v212, v89, v91
    v_cvt_pk_bf16_f32 v213, v93, v95
    v_cvt_pk_bf16_f32 v214, v97, v99
    v_cvt_pk_bf16_f32 v215, v101, v103
    buffer_store_dwordx4 v[212:215], v41, s[64:67], s87 offen offset:2048 sc0 sc1
    v_cvt_pk_bf16_f32 v216, v72, v74
    v_cvt_pk_bf16_f32 v217, v76, v78
    v_cvt_pk_bf16_f32 v218, v80, v82
    v_cvt_pk_bf16_f32 v219, v84, v86
    buffer_store_dwordx4 v[216:219], v42, s[64:67], s87 offen offset:0 sc0 sc1
    v_cvt_pk_bf16_f32 v220, v73, v75
    v_cvt_pk_bf16_f32 v221, v77, v79
    v_cvt_pk_bf16_f32 v222, v81, v83
    v_cvt_pk_bf16_f32 v223, v85, v87
    buffer_store_dwordx4 v[220:223], v43, s[64:67], s87 offen offset:0 sc0 sc1
    v_cvt_pk_bf16_f32 v224, v104, v106
    v_cvt_pk_bf16_f32 v225, v108, v110
    v_cvt_pk_bf16_f32 v226, v112, v114
    v_cvt_pk_bf16_f32 v227, v116, v118
    buffer_store_dwordx4 v[224:227], v42, s[64:67], s87 offen offset:2048 sc0 sc1
    v_cvt_pk_bf16_f32 v228, v105, v107
    v_cvt_pk_bf16_f32 v229, v109, v111
    v_cvt_pk_bf16_f32 v230, v113, v115
    v_cvt_pk_bf16_f32 v231, v117, v119
    buffer_store_dwordx4 v[228:231], v43, s[64:67], s87 offen offset:2048 sc0 sc1
    s_barrier
    s_barrier
    s_barrier
    s_waitcnt vmcnt(0)
    s_lshl_b32 s79, s92, 3
    s_add_u32 s79, s79, 11354112
    v_mov_b32 v8, s46
    v_mov_b32 v9, s47
    s_mov_b64 exec, 1
    buffer_store_dwordx2 v[8:9], v4, s[64:67], s79 offen sc0 sc1
    s_mov_b64 exec, -1
    s_endpgm
L_c1:
    s_barrier
    ds_read_b128 v[184:187], v28 offset:0
    ds_read_b64_tr_b16 v[200:201], v36 offset:1024
    ds_read_b64_tr_b16 v[202:203], v36 offset:1280
    ds_read_b128 v[188:191], v28 offset:2048
    ds_read_b64_tr_b16 v[204:205], v36 offset:13312
    ds_read_b64_tr_b16 v[206:207], v36 offset:13568
    ds_read_b64_tr_b16 v[208:209], v36 offset:2048
    ds_read_b64_tr_b16 v[210:211], v36 offset:2304
    ds_read_b64_tr_b16 v[212:213], v36 offset:14336
    ds_read_b64_tr_b16 v[214:215], v36 offset:14592
    s_waitcnt lgkmcnt(7)
    v_mfma_f32_32x32x16_bf16 v[56:71], v[184:187], v[200:203], 0
    ds_read_b128 v[192:195], v29 offset:0
    ds_read_b64_tr_b16 v[216:217], v36 offset:4096
    s_waitcnt lgkmcnt(8)
    v_mfma_f32_32x32x16_bf16 v[72:87], v[188:191], v[200:203], 0
    ds_read_b64_tr_b16 v[218:219], v36 offset:4352
    ds_read_b128 v[196:199], v29 offset:2048
    s_waitcnt lgkmcnt(8)
    v_mfma_f32_32x32x16_bf16 v[88:103], v[184:187], v[204:207], 0
    ds_read_b64_tr_b16 v[220:221], v36 offset:16384
    v_mfma_f32_32x32x16_bf16 v[104:119], v[188:191], v[204:207], 0
    ds_read_b64_tr_b16 v[222:223], v36 offset:16640
    ds_read_b64_tr_b16 v[224:225], v36 offset:5120
    s_waitcnt lgkmcnt(9)
    v_mfma_f32_32x32x16_bf16 v[120:135], v[184:187], v[208:211], 0
    ds_read_b64_tr_b16 v[226:227], v36 offset:5376
    ds_read_b64_tr_b16 v[228:229], v36 offset:17408
    v_mfma_f32_32x32x16_bf16 v[136:151], v[188:191], v[208:211], 0
    ds_read_b64_tr_b16 v[230:231], v36 offset:17664
    s_waitcnt lgkmcnt(10)
    v_mfma_f32_32x32x16_bf16 v[152:167], v[184:187], v[212:215], 0
    v_mfma_f32_32x32x16_bf16 v[168:183], v[188:191], v[212:215], 0
    s_waitcnt lgkmcnt(7)
    v_mfma_f32_32x32x16_bf16 v[56:71], v[192:195], v[216:219], v[56:71]
    ds_read_b128 v[184:187], v30 offset:0
    ds_read_b64_tr_b16 v[200:201], v36 offset:7168
    s_waitcnt lgkmcnt(8)
    v_mfma_f32_32x32x16_bf16 v[72:87], v[196:199], v[216:219], v[72:87]
    ds_read_b64_tr_b16 v[202:203], v36 offset:7424
    ds_read_b128 v[188:191], v30 offset:2048
    s_waitcnt lgkmcnt(8)
    v_mfma_f32_32x32x16_bf16 v[88:103], v[192:195], v[220:223], v[88:103]
    ds_read_b64_tr_b16 v[204:205], v36 offset:19456
    v_mfma_f32_32x32x16_bf16 v[104:119], v[196:199], v[220:223], v[104:119]
    ds_read_b64_tr_b16 v[206:207], v36 offset:19712
    ds_read_b64_tr_b16 v[208:209], v36 offset:8192
    s_waitcnt lgkmcnt(9)
    v_mfma_f32_32x32x16_bf16 v[120:135], v[192:195], v[224:227], v[120:135]
    ds_read_b64_tr_b16 v[210:211], v36 offset:8448
    ds_read_b64_tr_b16 v[212:213], v36 offset:20480
    v_mfma_f32_32x32x16_bf16 v[136:151], v[196:199], v[224:227], v[136:151]
    ds_read_b64_tr_b16 v[214:215], v36 offset:20736
    s_waitcnt lgkmcnt(10)
    v_mfma_f32_32x32x16_bf16 v[152:167], v[192:195], v[228:231], v[152:167]
    v_mfma_f32_32x32x16_bf16 v[168:183], v[196:199], v[228:231], v[168:183]
    s_waitcnt lgkmcnt(7)
    v_mfma_f32_32x32x16_bf16 v[56:71], v[184:187], v[200:203], v[56:71]
    ds_read_b128 v[192:195], v31 offset:0
    ds_read_b64_tr_b16 v[216:217], v36 offset:10240
    s_waitcnt lgkmcnt(8)
    v_mfma_f32_32x32x16_bf16 v[72:87], v[188:191], v[200:203], v[72:87]
    ds_read_b64_tr_b16 v[218:219], v36 offset:10496
    ds_read_b128 v[196:199], v31 offset:2048
    s_waitcnt lgkmcnt(8)
    v_mfma_f32_32x32x16_bf16 v[88:103], v[184:187], v[204:207], v[88:103]
    ds_read_b64_tr_b16 v[220:221], v36 offset:22528
    v_mfma_f32_32x32x16_bf16 v[104:119], v[188:191], v[204:207], v[104:119]
    ds_read_b64_tr_b16 v[222:223], v36 offset:22784
    ds_read_b64_tr_b16 v[224:225], v36 offset:11264
    s_waitcnt lgkmcnt(9)
    v_mfma_f32_32x32x16_bf16 v[120:135], v[184:187], v[208:211], v[120:135]
    ds_read_b64_tr_b16 v[226:227], v36 offset:11520
    ds_read_b64_tr_b16 v[228:229], v36 offset:23552
    v_mfma_f32_32x32x16_bf16 v[136:151], v[188:191], v[208:211], v[136:151]
    ds_read_b64_tr_b16 v[230:231], v36 offset:23808
    s_waitcnt lgkmcnt(10)
    v_mfma_f32_32x32x16_bf16 v[152:167], v[184:187], v[212:215], v[152:167]
    v_mfma_f32_32x32x16_bf16 v[168:183], v[188:191], v[212:215], v[168:183]
    s_waitcnt lgkmcnt(0)
    s_barrier
    v_mfma_f32_32x32x16_bf16 v[56:71], v[192:195], v[216:219], v[56:71]
    v_add_u32 v28, 49152, v28
    v_add_u32 v36, 49152, v36
    ds_read_b128 v[184:187], v28 offset:0
    v_mfma_f32_32x32x16_bf16 v[72:87], v[196:199], v[216:219], v[72:87]
    ds_read_b64_tr_b16 v[200:201], v36 offset:1024
    ds_read_b64_tr_b16 v[202:203], v36 offset:1280
    v_mfma_f32_32x32x16_bf16 v[88:103], v[192:195], v[220:223], v[88:103]
    ds_read_b128 v[188:191], v28 offset:2048
    ds_read_b64_tr_b16 v[204:205], v36 offset:13312
    ds_read_b64_tr_b16 v[206:207], v36 offset:13568
    v_mfma_f32_32x32x16_bf16 v[104:119], v[196:199], v[220:223], v[104:119]
    ds_read_b64_tr_b16 v[208:209], v36 offset:2048
    ds_read_b64_tr_b16 v[210:211], v36 offset:2304
    v_mfma_f32_32x32x16_bf16 v[120:135], v[192:195], v[224:227], v[120:135]
    ds_read_b64_tr_b16 v[212:213], v36 offset:14336
    ds_read_b64_tr_b16 v[214:215], v36 offset:14592
    v_add_u32 v29, 49152, v29
    v_mfma_f32_32x32x16_bf16 v[136:151], v[196:199], v[224:227], v[136:151]
    v_add_u32 v30, 49152, v30
    v_add_u32 v31, 49152, v31
    v_mfma_f32_32x32x16_bf16 v[152:167], v[192:195], v[228:231], v[152:167]
    v_mfma_f32_32x32x16_bf16 v[168:183], v[196:199], v[228:231], v[168:183]
    s_waitcnt lgkmcnt(7)
    v_mfma_f32_32x32x16_bf16 v[56:71], v[184:187], v[200:203], v[56:71]
    ds_read_b128 v[192:195], v29 offset:0
    ds_read_b64_tr_b16 v[216:217], v36 offset:4096
    s_waitcnt lgkmcnt(8)
    v_mfma_f32_32x32x16_bf16 v[72:87], v[188:191], v[200:203], v[72:87]
    ds_read_b64_tr_b16 v[218:219], v36 offset:4352
    ds_read_b128 v[196:199], v29 offset:2048
    s_waitcnt lgkmcnt(8)
    v_mfma_f32_32x32x16_bf16 v[88:103], v[184:187], v[204:207], v[88:103]
    ds_read_b64_tr_b16 v[220:221], v36 offset:16384
    v_mfma_f32_32x32x16_bf16 v[104:119], v[188:191], v[204:207], v[104:119]
    ds_read_b64_tr_b16 v[222:223], v36 offset:16640
    ds_read_b64_tr_b16 v[224:225], v36 offset:5120
    s_waitcnt lgkmcnt(9)
    v_mfma_f32_32x32x16_bf16 v[120:135], v[184:187], v[208:211], v[120:135]
    ds_read_b64_tr_b16 v[226:227], v36 offset:5376
    ds_read_b64_tr_b16 v[228:229], v36 offset:17408
    v_mfma_f32_32x32x16_bf16 v[136:151], v[188:191], v[208:211], v[136:151]
    ds_read_b64_tr_b16 v[230:231], v36 offset:17664
    s_waitcnt lgkmcnt(10)
    v_mfma_f32_32x32x16_bf16 v[152:167], v[184:187], v[212:215], v[152:167]
    v_mfma_f32_32x32x16_bf16 v[168:183], v[188:191], v[212:215], v[168:183]
    s_waitcnt lgkmcnt(7)
    v_mfma_f32_32x32x16_bf16 v[56:71], v[192:195], v[216:219], v[56:71]
    ds_read_b128 v[184:187], v30 offset:0
    ds_read_b64_tr_b16 v[200:201], v36 offset:7168
    s_waitcnt lgkmcnt(8)
    v_mfma_f32_32x32x16_bf16 v[72:87], v[196:199], v[216:219], v[72:87]
    ds_read_b64_tr_b16 v[202:203], v36 offset:7424
    ds_read_b128 v[188:191], v30 offset:2048
    s_waitcnt lgkmcnt(8)
    v_mfma_f32_32x32x16_bf16 v[88:103], v[192:195], v[220:223], v[88:103]
    ds_read_b64_tr_b16 v[204:205], v36 offset:19456
    v_mfma_f32_32x32x16_bf16 v[104:119], v[196:199], v[220:223], v[104:119]
    ds_read_b64_tr_b16 v[206:207], v36 offset:19712
    ds_read_b64_tr_b16 v[208:209], v36 offset:8192
    s_waitcnt lgkmcnt(9)
    v_mfma_f32_32x32x16_bf16 v[120:135], v[192:195], v[224:227], v[120:135]
    ds_read_b64_tr_b16 v[210:211], v36 offset:8448
    ds_read_b64_tr_b16 v[212:213], v36 offset:20480
    v_mfma_f32_32x32x16_bf16 v[136:151], v[196:199], v[224:227], v[136:151]
    ds_read_b64_tr_b16 v[214:215], v36 offset:20736
    s_waitcnt lgkmcnt(10)
    v_mfma_f32_32x32x16_bf16 v[152:167], v[192:195], v[228:231], v[152:167]
    v_mfma_f32_32x32x16_bf16 v[168:183], v[196:199], v[228:231], v[168:183]
    s_waitcnt lgkmcnt(7)
    v_mfma_f32_32x32x16_bf16 v[56:71], v[184:187], v[200:203], v[56:71]
    ds_read_b128 v[192:195], v31 offset:0
    ds_read_b64_tr_b16 v[216:217], v36 offset:10240
    s_waitcnt lgkmcnt(8)
    v_mfma_f32_32x32x16_bf16 v[72:87], v[188:191], v[200:203], v[72:87]
    ds_read_b64_tr_b16 v[218:219], v36 offset:10496
    ds_read_b128 v[196:199], v31 offset:2048
    s_waitcnt lgkmcnt(8)
    v_mfma_f32_32x32x16_bf16 v[88:103], v[184:187], v[204:207], v[88:103]
    ds_read_b64_tr_b16 v[220:221], v36 offset:22528
    v_mfma_f32_32x32x16_bf16 v[104:119], v[188:191], v[204:207], v[104:119]
    ds_read_b64_tr_b16 v[222:223], v36 offset:22784
    ds_read_b64_tr_b16 v[224:225], v36 offset:11264
    s_waitcnt lgkmcnt(9)
    v_mfma_f32_32x32x16_bf16 v[120:135], v[184:187], v[208:211], v[120:135]
    ds_read_b64_tr_b16 v[226:227], v36 offset:11520
    ds_read_b64_tr_b16 v[228:229], v36 offset:23552
    v_mfma_f32_32x32x16_bf16 v[136:151], v[188:191], v[208:211], v[136:151]
    ds_read_b64_tr_b16 v[230:231], v36 offset:23808
    s_waitcnt lgkmcnt(10)
    v_mfma_f32_32x32x16_bf16 v[152:167], v[184:187], v[212:215], v[152:167]
    v_mfma_f32_32x32x16_bf16 v[168:183], v[188:191], v[212:215], v[168:183]
    s_waitcnt lgkmcnt(0)
    s_barrier
    v_mfma_f32_32x32x16_bf16 v[56:71], v[192:195], v[216:219], v[56:71]
    v_add_u32 v28, 49152, v28
    v_add_u32 v36, 49152, v36
    ds_read_b128 v[184:187], v28 offset:0
    v_mfma_f32_32x32x16_bf16 v[72:87], v[196:199], v[216:219], v[72:87]
    ds_read_b64_tr_b16 v[200:201], v36 offset:1024
    ds_read_b64_tr_b16 v[202:203], v36 offset:1280
    v_mfma_f32_32x32x16_bf16 v[88:103], v[192:195], v[220:223], v[88:103]
    ds_read_b128 v[188:191], v28 offset:2048
    ds_read_b64_tr_b16 v[204:205], v36 offset:13312
    ds_read_b64_tr_b16 v[206:207], v36 offset:13568
    v_mfma_f32_32x32x16_bf16 v[104:119], v[196:199], v[220:223], v[104:119]
    ds_read_b64_tr_b16 v[208:209], v36 offset:2048
    ds_read_b64_tr_b16 v[210:211], v36 offset:2304
    v_mfma_f32_32x32x16_bf16 v[120:135], v[192:195], v[224:227], v[120:135]
    ds_read_b64_tr_b16 v[212:213], v36 offset:14336
    ds_read_b64_tr_b16 v[214:215], v36 offset:14592
    v_add_u32 v29, 49152, v29
    v_mfma_f32_32x32x16_bf16 v[136:151], v[196:199], v[224:227], v[136:151]
    v_add_u32 v30, 49152, v30
    v_add_u32 v31, 49152, v31
    v_mfma_f32_32x32x16_bf16 v[152:167], v[192:195], v[228:231], v[152:167]
    v_mfma_f32_32x32x16_bf16 v[168:183], v[196:199], v[228:231], v[168:183]
    s_waitcnt lgkmcnt(7)
    v_mfma_f32_32x32x16_bf16 v[56:71], v[184:187], v[200:203], v[56:71]
    ds_read_b128 v[192:195], v29 offset:0
    ds_read_b64_tr_b16 v[216:217], v36 offset:4096
    s_waitcnt lgkmcnt(8)
    v_mfma_f32_32x32x16_bf16 v[72:87], v[188:191], v[200:203], v[72:87]
    ds_read_b64_tr_b16 v[218:219], v36 offset:4352
    ds_read_b128 v[196:199], v29 offset:2048
    s_waitcnt lgkmcnt(8)
    v_mfma_f32_32x32x16_bf16 v[88:103], v[184:187], v[204:207], v[88:103]
    ds_read_b64_tr_b16 v[220:221], v36 offset:16384
    v_mfma_f32_32x32x16_bf16 v[104:119], v[188:191], v[204:207], v[104:119]
    ds_read_b64_tr_b16 v[222:223], v36 offset:16640
    ds_read_b64_tr_b16 v[224:225], v36 offset:5120
    s_waitcnt lgkmcnt(9)
    v_mfma_f32_32x32x16_bf16 v[120:135], v[184:187], v[208:211], v[120:135]
    ds_read_b64_tr_b16 v[226:227], v36 offset:5376
    ds_read_b64_tr_b16 v[228:229], v36 offset:17408
    v_mfma_f32_32x32x16_bf16 v[136:151], v[188:191], v[208:211], v[136:151]
    ds_read_b64_tr_b16 v[230:231], v36 offset:17664
    s_waitcnt lgkmcnt(10)
    v_mfma_f32_32x32x16_bf16 v[152:167], v[184:187], v[212:215], v[152:167]
    v_mfma_f32_32x32x16_bf16 v[168:183], v[188:191], v[212:215], v[168:183]
    s_waitcnt lgkmcnt(7)
    v_mfma_f32_32x32x16_bf16 v[56:71], v[192:195], v[216:219], v[56:71]
    ds_read_b128 v[184:187], v30 offset:0
    ds_read_b64_tr_b16 v[200:201], v36 offset:7168
    s_waitcnt lgkmcnt(8)
    v_mfma_f32_32x32x16_bf16 v[72:87], v[196:199], v[216:219], v[72:87]
    ds_read_b64_tr_b16 v[202:203], v36 offset:7424
    ds_read_b128 v[188:191], v30 offset:2048
    s_waitcnt lgkmcnt(8)
    v_mfma_f32_32x32x16_bf16 v[88:103], v[192:195], v[220:223], v[88:103]
    ds_read_b64_tr_b16 v[204:205], v36 offset:19456
    v_mfma_f32_32x32x16_bf16 v[104:119], v[196:199], v[220:223], v[104:119]
    ds_read_b64_tr_b16 v[206:207], v36 offset:19712
    ds_read_b64_tr_b16 v[208:209], v36 offset:8192
    s_waitcnt lgkmcnt(9)
    v_mfma_f32_32x32x16_bf16 v[120:135], v[192:195], v[224:227], v[120:135]
    ds_read_b64_tr_b16 v[210:211], v36 offset:8448
    ds_read_b64_tr_b16 v[212:213], v36 offset:20480
    v_mfma_f32_32x32x16_bf16 v[136:151], v[196:199], v[224:227], v[136:151]
    ds_read_b64_tr_b16 v[214:215], v36 offset:20736
    s_waitcnt lgkmcnt(10)
    v_mfma_f32_32x32x16_bf16 v[152:167], v[192:195], v[228:231], v[152:167]
    v_mfma_f32_32x32x16_bf16 v[168:183], v[196:199], v[228:231], v[168:183]
    s_waitcnt lgkmcnt(7)
    v_mfma_f32_32x32x16_bf16 v[56:71], v[184:187], v[200:203], v[56:71]
    ds_read_b128 v[192:195], v31 offset:0
    ds_read_b64_tr_b16 v[216:217], v36 offset:10240
    s_waitcnt lgkmcnt(8)
    v_mfma_f32_32x32x16_bf16 v[72:87], v[188:191], v[200:203], v[72:87]
    ds_read_b64_tr_b16 v[218:219], v36 offset:10496
    ds_read_b128 v[196:199], v31 offset:2048
    s_waitcnt lgkmcnt(8)
    v_mfma_f32_32x32x16_bf16 v[88:103], v[184:187], v[204:207], v[88:103]
    ds_read_b64_tr_b16 v[220:221], v36 offset:22528
    v_mfma_f32_32x32x16_bf16 v[104:119], v[188:191], v[204:207], v[104:119]
    ds_read_b64_tr_b16 v[222:223], v36 offset:22784
    ds_read_b64_tr_b16 v[224:225], v36 offset:11264
    s_waitcnt lgkmcnt(9)
    v_mfma_f32_32x32x16_bf16 v[120:135], v[184:187], v[208:211], v[120:135]
    ds_read_b64_tr_b16 v[226:227], v36 offset:11520
    ds_read_b64_tr_b16 v[228:229], v36 offset:23552
    v_mfma_f32_32x32x16_bf16 v[136:151], v[188:191], v[208:211], v[136:151]
    ds_read_b64_tr_b16 v[230:231], v36 offset:23808
    s_waitcnt lgkmcnt(10)
    v_mfma_f32_32x32x16_bf16 v[152:167], v[184:187], v[212:215], v[152:167]
    v_mfma_f32_32x32x16_bf16 v[168:183], v[188:191], v[212:215], v[168:183]
    s_waitcnt lgkmcnt(0)
    s_barrier
    v_mfma_f32_32x32x16_bf16 v[56:71], v[192:195], v[216:219], v[56:71]
    v_add_u32 v28, 4294868992, v28
    v_add_u32 v36, 4294868992, v36
    ds_read_b128 v[184:187], v28 offset:0
    v_mfma_f32_32x32x16_bf16 v[72:87], v[196:199], v[216:219], v[72:87]
    ds_read_b64_tr_b16 v[200:201], v36 offset:1024
    ds_read_b64_tr_b16 v[202:203], v36 offset:1280
    v_mfma_f32_32x32x16_bf16 v[88:103], v[192:195], v[220:223], v[88:103]
    ds_read_b128 v[188:191], v28 offset:2048
    ds_read_b64_tr_b16 v[204:205], v36 offset:13312
    ds_read_b64_tr_b16 v[206:207], v36 offset:13568
    v_mfma_f32_32x32x16_bf16 v[104:119], v[196:199], v[220:223], v[104:119]
    ds_read_b64_tr_b16 v[208:209], v36 offset:2048
    ds_read_b64_tr_b16 v[210:211], v36 offset:2304
    v_mfma_f32_32x32x16_bf16 v[120:135], v[192:195], v[224:227], v[120:135]
    ds_read_b64_tr_b16 v[212:213], v36 offset:14336
    ds_read_b64_tr_b16 v[214:215], v36 offset:14592
    v_add_u32 v29, 4294868992, v29
    v_mfma_f32_32x32x16_bf16 v[136:151], v[196:199], v[224:227], v[136:151]
    v_add_u32 v30, 4294868992, v30
    v_add_u32 v31, 4294868992, v31
    v_mfma_f32_32x32x16_bf16 v[152:167], v[192:195], v[228:231], v[152:167]
    v_mfma_f32_32x32x16_bf16 v[168:183], v[196:199], v[228:231], v[168:183]
    s_waitcnt lgkmcnt(7)
    v_mfma_f32_32x32x16_bf16 v[56:71], v[184:187], v[200:203], v[56:71]
    ds_read_b128 v[192:195], v29 offset:0
    ds_read_b64_tr_b16 v[216:217], v36 offset:4096
    s_waitcnt lgkmcnt(8)
    v_mfma_f32_32x32x16_bf16 v[72:87], v[188:191], v[200:203], v[72:87]
    ds_read_b64_tr_b16 v[218:219], v36 offset:4352
    ds_read_b128 v[196:199], v29 offset:2048
    s_waitcnt lgkmcnt(8)
    v_mfma_f32_32x32x16_bf16 v[88:103], v[184:187], v[204:207], v[88:103]
    ds_read_b64_tr_b16 v[220:221], v36 offset:16384
    v_mfma_f32_32x32x16_bf16 v[104:119], v[188:191], v[204:207], v[104:119]
    ds_read_b64_tr_b16 v[222:223], v36 offset:16640
    ds_read_b64_tr_b16 v[224:225], v36 offset:5120
    s_waitcnt lgkmcnt(9)
    v_mfma_f32_32x32x16_bf16 v[120:135], v[184:187], v[208:211], v[120:135]
    ds_read_b64_tr_b16 v[226:227], v36 offset:5376
    ds_read_b64_tr_b16 v[228:229], v36 offset:17408
    v_mfma_f32_32x32x16_bf16 v[136:151], v[188:191], v[208:211], v[136:151]
    ds_read_b64_tr_b16 v[230:231], v36 offset:17664
    s_waitcnt lgkmcnt(10)
    v_mfma_f32_32x32x16_bf16 v[152:167], v[184:187], v[212:215], v[152:167]
    v_mfma_f32_32x32x16_bf16 v[168:183], v[188:191], v[212:215], v[168:183]
    s_waitcnt lgkmcnt(7)
    v_mfma_f32_32x32x16_bf16 v[56:71], v[192:195], v[216:219], v[56:71]
    ds_read_b128 v[184:187], v30 offset:0
    ds_read_b64_tr_b16 v[200:201], v36 offset:7168
    s_waitcnt lgkmcnt(8)
    v_mfma_f32_32x32x16_bf16 v[72:87], v[196:199], v[216:219], v[72:87]
    ds_read_b64_tr_b16 v[202:203], v36 offset:7424
    ds_read_b128 v[188:191], v30 offset:2048
    s_waitcnt lgkmcnt(8)
    v_mfma_f32_32x32x16_bf16 v[88:103], v[192:195], v[220:223], v[88:103]
    ds_read_b64_tr_b16 v[204:205], v36 offset:19456
    v_mfma_f32_32x32x16_bf16 v[104:119], v[196:199], v[220:223], v[104:119]
    ds_read_b64_tr_b16 v[206:207], v36 offset:19712
    ds_read_b64_tr_b16 v[208:209], v36 offset:8192
    s_waitcnt lgkmcnt(9)
    v_mfma_f32_32x32x16_bf16 v[120:135], v[192:195], v[224:227], v[120:135]
    ds_read_b64_tr_b16 v[210:211], v36 offset:8448
    ds_read_b64_tr_b16 v[212:213], v36 offset:20480
    v_mfma_f32_32x32x16_bf16 v[136:151], v[196:199], v[224:227], v[136:151]
    ds_read_b64_tr_b16 v[214:215], v36 offset:20736
    s_waitcnt lgkmcnt(10)
    v_mfma_f32_32x32x16_bf16 v[152:167], v[192:195], v[228:231], v[152:167]
    v_mfma_f32_32x32x16_bf16 v[168:183], v[196:199], v[228:231], v[168:183]
    s_waitcnt lgkmcnt(7)
    v_mfma_f32_32x32x16_bf16 v[56:71], v[184:187], v[200:203], v[56:71]
    ds_read_b128 v[192:195], v31 offset:0
    ds_read_b64_tr_b16 v[216:217], v36 offset:10240
    s_waitcnt lgkmcnt(8)
    v_mfma_f32_32x32x16_bf16 v[72:87], v[188:191], v[200:203], v[72:87]
    ds_read_b64_tr_b16 v[218:219], v36 offset:10496
    ds_read_b128 v[196:199], v31 offset:2048
    s_waitcnt lgkmcnt(8)
    v_mfma_f32_32x32x16_bf16 v[88:103], v[184:187], v[204:207], v[88:103]
    ds_read_b64_tr_b16 v[220:221], v36 offset:22528
    v_mfma_f32_32x32x16_bf16 v[104:119], v[188:191], v[204:207], v[104:119]
    ds_read_b64_tr_b16 v[222:223], v36 offset:22784
    ds_read_b64_tr_b16 v[224:225], v36 offset:11264
    s_waitcnt lgkmcnt(9)
    v_mfma_f32_32x32x16_bf16 v[120:135], v[184:187], v[208:211], v[120:135]
    ds_read_b64_tr_b16 v[226:227], v36 offset:11520
    ds_read_b64_tr_b16 v[228:229], v36 offset:23552
    v_mfma_f32_32x32x16_bf16 v[136:151], v[188:191], v[208:211], v[136:151]
    ds_read_b64_tr_b16 v[230:231], v36 offset:23808
    s_waitcnt lgkmcnt(10)
    v_mfma_f32_32x32x16_bf16 v[152:167], v[184:187], v[212:215], v[152:167]
    v_mfma_f32_32x32x16_bf16 v[168:183], v[188:191], v[212:215], v[168:183]
    s_waitcnt lgkmcnt(0)
    s_barrier
    v_mfma_f32_32x32x16_bf16 v[56:71], v[192:195], v[216:219], v[56:71]
    v_add_u32 v28, 49152, v28
    v_add_u32 v36, 49152, v36
    ds_read_b128 v[184:187], v28 offset:0
    v_mfma_f32_32x32x16_bf16 v[72:87], v[196:199], v[216:219], v[72:87]
    ds_read_b64_tr_b16 v[200:201], v36 offset:1024
    ds_read_b64_tr_b16 v[202:203], v36 offset:1280
    v_mfma_f32_32x32x16_bf16 v[88:103], v[192:195], v[220:223], v[88:103]
    ds_read_b128 v[188:191], v28 offset:2048
    ds_read_b64_tr_b16 v[204:205], v36 offset:13312
    ds_read_b64_tr_b16 v[206:207], v36 offset:13568
    v_mfma_f32_32x32x16_bf16 v[104:119], v[196:199], v[220:223], v[104:119]
    ds_read_b64_tr_b16 v[208:209], v36 offset:2048
    ds_read_b64_tr_b16 v[210:211], v36 offset:2304
    v_mfma_f32_32x32x16_bf16 v[120:135], v[192:195], v[224:227], v[120:135]
    ds_read_b64_tr_b16 v[212:213], v36 offset:14336
    ds_read_b64_tr_b16 v[214:215], v36 offset:14592
    v_add_u32 v29, 49152, v29
    v_mfma_f32_32x32x16_bf16 v[136:151], v[196:199], v[224:227], v[136:151]
    v_add_u32 v30, 49152, v30
    v_add_u32 v31, 49152, v31
    v_mfma_f32_32x32x16_bf16 v[152:167], v[192:195], v[228:231], v[152:167]
    v_mfma_f32_32x32x16_bf16 v[168:183], v[196:199], v[228:231], v[168:183]
    s_waitcnt lgkmcnt(7)
    v_mfma_f32_32x32x16_bf16 v[56:71], v[184:187], v[200:203], v[56:71]
    ds_read_b128 v[192:195], v29 offset:0
    ds_read_b64_tr_b16 v[216:217], v36 offset:4096
    s_waitcnt lgkmcnt(8)
    v_mfma_f32_32x32x16_bf16 v[72:87], v[188:191], v[200:203], v[72:87]
    ds_read_b64_tr_b16 v[218:219], v36 offset:4352
    ds_read_b128 v[196:199], v29 offset:2048
    s_waitcnt lgkmcnt(8)
    v_mfma_f32_32x32x16_bf16 v[88:103], v[184:187], v[204:207], v[88:103]
    ds_read_b64_tr_b16 v[220:221], v36 offset:16384
    v_mfma_f32_32x32x16_bf16 v[104:119], v[188:191], v[204:207], v[104:119]
    ds_read_b64_tr_b16 v[222:223], v36 offset:16640
    ds_read_b64_tr_b16 v[224:225], v36 offset:5120
    s_waitcnt lgkmcnt(9)
    v_mfma_f32_32x32x16_bf16 v[120:135], v[184:187], v[208:211], v[120:135]
    ds_read_b64_tr_b16 v[226:227], v36 offset:5376
    ds_read_b64_tr_b16 v[228:229], v36 offset:17408
    v_mfma_f32_32x32x16_bf16 v[136:151], v[188:191], v[208:211], v[136:151]
    ds_read_b64_tr_b16 v[230:231], v36 offset:17664
    s_waitcnt lgkmcnt(10)
    v_mfma_f32_32x32x16_bf16 v[152:167], v[184:187], v[212:215], v[152:167]
    v_mfma_f32_32x32x16_bf16 v[168:183], v[188:191], v[212:215], v[168:183]
    s_waitcnt lgkmcnt(7)
    v_mfma_f32_32x32x16_bf16 v[56:71], v[192:195], v[216:219], v[56:71]
    ds_read_b128 v[184:187], v30 offset:0
    ds_read_b64_tr_b16 v[200:201], v36 offset:7168
    s_waitcnt lgkmcnt(8)
    v_mfma_f32_32x32x16_bf16 v[72:87], v[196:199], v[216:219], v[72:87]
    ds_read_b64_tr_b16 v[202:203], v36 offset:7424
    ds_read_b128 v[188:191], v30 offset:2048
    s_waitcnt lgkmcnt(8)
    v_mfma_f32_32x32x16_bf16 v[88:103], v[192:195], v[220:223], v[88:103]
    ds_read_b64_tr_b16 v[204:205], v36 offset:19456
    v_mfma_f32_32x32x16_bf16 v[104:119], v[196:199], v[220:223], v[104:119]
    ds_read_b64_tr_b16 v[206:207], v36 offset:19712
    ds_read_b64_tr_b16 v[208:209], v36 offset:8192
    s_waitcnt lgkmcnt(9)
    v_mfma_f32_32x32x16_bf16 v[120:135], v[192:195], v[224:227], v[120:135]
    ds_read_b64_tr_b16 v[210:211], v36 offset:8448
    ds_read_b64_tr_b16 v[212:213], v36 offset:20480
    v_mfma_f32_32x32x16_bf16 v[136:151], v[196:199], v[224:227], v[136:151]
    ds_read_b64_tr_b16 v[214:215], v36 offset:20736
    s_waitcnt lgkmcnt(10)
    v_mfma_f32_32x32x16_bf16 v[152:167], v[192:195], v[228:231], v[152:167]
    v_mfma_f32_32x32x16_bf16 v[168:183], v[196:199], v[228:231], v[168:183]
    s_waitcnt lgkmcnt(7)
    v_mfma_f32_32x32x16_bf16 v[56:71], v[184:187], v[200:203], v[56:71]
    ds_read_b128 v[192:195], v31 offset:0
    ds_read_b64_tr_b16 v[216:217], v36 offset:10240
    s_waitcnt lgkmcnt(8)
    v_mfma_f32_32x32x16_bf16 v[72:87], v[188:191], v[200:203], v[72:87]
    ds_read_b64_tr_b16 v[218:219], v36 offset:10496
    ds_read_b128 v[196:199], v31 offset:2048
    s_waitcnt lgkmcnt(8)
    v_mfma_f32_32x32x16_bf16 v[88:103], v[184:187], v[204:207], v[88:103]
    ds_read_b64_tr_b16 v[220:221], v36 offset:22528
    v_mfma_f32_32x32x16_bf16 v[104:119], v[188:191], v[204:207], v[104:119]
    ds_read_b64_tr_b16 v[222:223], v36 offset:22784
    ds_read_b64_tr_b16 v[224:225], v36 offset:11264
    s_waitcnt lgkmcnt(9)
    v_mfma_f32_32x32x16_bf16 v[120:135], v[184:187], v[208:211], v[120:135]
    ds_read_b64_tr_b16 v[226:227], v36 offset:11520
    ds_read_b64_tr_b16 v[228:229], v36 offset:23552
    v_mfma_f32_32x32x16_bf16 v[136:151], v[188:191], v[208:211], v[136:151]
    ds_read_b64_tr_b16 v[230:231], v36 offset:23808
    s_waitcnt lgkmcnt(10)
    v_mfma_f32_32x32x16_bf16 v[152:167], v[184:187], v[212:215], v[152:167]
    v_mfma_f32_32x32x16_bf16 v[168:183], v[188:191], v[212:215], v[168:183]
    s_waitcnt lgkmcnt(0)
    s_barrier
    v_mfma_f32_32x32x16_bf16 v[56:71], v[192:195], v[216:219], v[56:71]
    v_add_u32 v28, 49152, v28
    v_add_u32 v36, 49152, v36
    ds_read_b128 v[184:187], v28 offset:0
    v_mfma_f32_32x32x16_bf16 v[72:87], v[196:199], v[216:219], v[72:87]
    ds_read_b64_tr_b16 v[200:201], v36 offset:1024
    ds_read_b64_tr_b16 v[202:203], v36 offset:1280
    v_mfma_f32_32x32x16_bf16 v[88:103], v[192:195], v[220:223], v[88:103]
    ds_read_b128 v[188:191], v28 offset:2048
    ds_read_b64_tr_b16 v[204:205], v36 offset:13312
    ds_read_b64_tr_b16 v[206:207], v36 offset:13568
    v_mfma_f32_32x32x16_bf16 v[104:119], v[196:199], v[220:223], v[104:119]
    ds_read_b64_tr_b16 v[208:209], v36 offset:2048
    ds_read_b64_tr_b16 v[210:211], v36 offset:2304
    v_mfma_f32_32x32x16_bf16 v[120:135], v[192:195], v[224:227], v[120:135]
    ds_read_b64_tr_b16 v[212:213], v36 offset:14336
    ds_read_b64_tr_b16 v[214:215], v36 offset:14592
    v_add_u32 v29, 49152, v29
    v_mfma_f32_32x32x16_bf16 v[136:151], v[196:199], v[224:227], v[136:151]
    v_add_u32 v30, 49152, v30
    v_add_u32 v31, 49152, v31
    v_mfma_f32_32x32x16_bf16 v[152:167], v[192:195], v[228:231], v[152:167]
    v_mfma_f32_32x32x16_bf16 v[168:183], v[196:199], v[228:231], v[168:183]
    s_waitcnt lgkmcnt(7)
    v_mfma_f32_32x32x16_bf16 v[56:71], v[184:187], v[200:203], v[56:71]
    ds_read_b128 v[192:195], v29 offset:0
    ds_read_b64_tr_b16 v[216:217], v36 offset:4096
    s_waitcnt lgkmcnt(8)
    v_mfma_f32_32x32x16_bf16 v[72:87], v[188:191], v[200:203], v[72:87]
    ds_read_b64_tr_b16 v[218:219], v36 offset:4352
    ds_read_b128 v[196:199], v29 offset:2048
    s_waitcnt lgkmcnt(8)
    v_mfma_f32_32x32x16_bf16 v[88:103], v[184:187], v[204:207], v[88:103]
    ds_read_b64_tr_b16 v[220:221], v36 offset:16384
    v_mfma_f32_32x32x16_bf16 v[104:119], v[188:191], v[204:207], v[104:119]
    ds_read_b64_tr_b16 v[222:223], v36 offset:16640
    ds_read_b64_tr_b16 v[224:225], v36 offset:5120
    s_waitcnt lgkmcnt(9)
    v_mfma_f32_32x32x16_bf16 v[120:135], v[184:187], v[208:211], v[120:135]
    ds_read_b64_tr_b16 v[226:227], v36 offset:5376
    ds_read_b64_tr_b16 v[228:229], v36 offset:17408
    v_mfma_f32_32x32x16_bf16 v[136:151], v[188:191], v[208:211], v[136:151]
    ds_read_b64_tr_b16 v[230:231], v36 offset:17664
    s_waitcnt lgkmcnt(10)
    v_mfma_f32_32x32x16_bf16 v[152:167], v[184:187], v[212:215], v[152:167]
    v_mfma_f32_32x32x16_bf16 v[168:183], v[188:191], v[212:215], v[168:183]
    s_waitcnt lgkmcnt(7)
    v_mfma_f32_32x32x16_bf16 v[56:71], v[192:195], v[216:219], v[56:71]
    ds_read_b128 v[184:187], v30 offset:0
    ds_read_b64_tr_b16 v[200:201], v36 offset:7168
    s_waitcnt lgkmcnt(8)
    v_mfma_f32_32x32x16_bf16 v[72:87], v[196:199], v[216:219], v[72:87]
    ds_read_b64_tr_b16 v[202:203], v36 offset:7424
    ds_read_b128 v[188:191], v30 offset:2048
    s_waitcnt lgkmcnt(8)
    v_mfma_f32_32x32x16_bf16 v[88:103], v[192:195], v[220:223], v[88:103]
    ds_read_b64_tr_b16 v[204:205], v36 offset:19456
    v_mfma_f32_32x32x16_bf16 v[104:119], v[196:199], v[220:223], v[104:119]
    ds_read_b64_tr_b16 v[206:207], v36 offset:19712
    ds_read_b64_tr_b16 v[208:209], v36 offset:8192
    s_waitcnt lgkmcnt(9)
    v_mfma_f32_32x32x16_bf16 v[120:135], v[192:195], v[224:227], v[120:135]
    ds_read_b64_tr_b16 v[210:211], v36 offset:8448
    ds_read_b64_tr_b16 v[212:213], v36 offset:20480
    v_mfma_f32_32x32x16_bf16 v[136:151], v[196:199], v[224:227], v[136:151]
    ds_read_b64_tr_b16 v[214:215], v36 offset:20736
    s_waitcnt lgkmcnt(10)
    v_mfma_f32_32x32x16_bf16 v[152:167], v[192:195], v[228:231], v[152:167]
    v_mfma_f32_32x32x16_bf16 v[168:183], v[196:199], v[228:231], v[168:183]
    s_waitcnt lgkmcnt(7)
    v_mfma_f32_32x32x16_bf16 v[56:71], v[184:187], v[200:203], v[56:71]
    ds_read_b128 v[192:195], v31 offset:0
    ds_read_b64_tr_b16 v[216:217], v36 offset:10240
    s_waitcnt lgkmcnt(8)
    v_mfma_f32_32x32x16_bf16 v[72:87], v[188:191], v[200:203], v[72:87]
    ds_read_b64_tr_b16 v[218:219], v36 offset:10496
    ds_read_b128 v[196:199], v31 offset:2048
    s_waitcnt lgkmcnt(8)
    v_mfma_f32_32x32x16_bf16 v[88:103], v[184:187], v[204:207], v[88:103]
    ds_read_b64_tr_b16 v[220:221], v36 offset:22528
    v_mfma_f32_32x32x16_bf16 v[104:119], v[188:191], v[204:207], v[104:119]
    ds_read_b64_tr_b16 v[222:223], v36 offset:22784
    ds_read_b64_tr_b16 v[224:225], v36 offset:11264
    s_waitcnt lgkmcnt(9)
    v_mfma_f32_32x32x16_bf16 v[120:135], v[184:187], v[208:211], v[120:135]
    ds_read_b64_tr_b16 v[226:227], v36 offset:11520
    ds_read_b64_tr_b16 v[228:229], v36 offset:23552
    v_mfma_f32_32x32x16_bf16 v[136:151], v[188:191], v[208:211], v[136:151]
    ds_read_b64_tr_b16 v[230:231], v36 offset:23808
    s_waitcnt lgkmcnt(10)
    v_mfma_f32_32x32x16_bf16 v[152:167], v[184:187], v[212:215], v[152:167]
    v_mfma_f32_32x32x16_bf16 v[168:183], v[188:191], v[212:215], v[168:183]
    s_waitcnt lgkmcnt(0)
    s_barrier
    v_mfma_f32_32x32x16_bf16 v[56:71], v[192:195], v[216:219], v[56:71]
    v_add_u32 v28, 4294868992, v28
    v_add_u32 v36, 4294868992, v36
    ds_read_b128 v[184:187], v28 offset:0
    v_mfma_f32_32x32x16_bf16 v[72:87], v[196:199], v[216:219], v[72:87]
    ds_read_b64_tr_b16 v[200:201], v36 offset:1024
    ds_read_b64_tr_b16 v[202:203], v36 offset:1280
    v_mfma_f32_32x32x16_bf16 v[88:103], v[192:195], v[220:223], v[88:103]
    ds_read_b128 v[188:191], v28 offset:2048
    ds_read_b64_tr_b16 v[204:205], v36 offset:13312
    ds_read_b64_tr_b16 v[206:207], v36 offset:13568
    v_mfma_f32_32x32x16_bf16 v[104:119], v[196:199], v[220:223], v[104:119]
    ds_read_b64_tr_b16 v[208:209], v36 offset:2048
    ds_read_b64_tr_b16 v[210:211], v36 offset:2304
    v_mfma_f32_32x32x16_bf16 v[120:135], v[192:195], v[224:227], v[120:135]
    ds_read_b64_tr_b16 v[212:213], v36 offset:14336
    ds_read_b64_tr_b16 v[214:215], v36 offset:14592
    v_add_u32 v29, 4294868992, v29
    v_mfma_f32_32x32x16_bf16 v[136:151], v[196:199], v[224:227], v[136:151]
    v_add_u32 v30, 4294868992, v30
    v_add_u32 v31, 4294868992, v31
    v_mfma_f32_32x32x16_bf16 v[152:167], v[192:195], v[228:231], v[152:167]
    v_mfma_f32_32x32x16_bf16 v[168:183], v[196:199], v[228:231], v[168:183]
    s_waitcnt lgkmcnt(7)
    v_mfma_f32_32x32x16_bf16 v[56:71], v[184:187], v[200:203], v[56:71]
    ds_read_b128 v[192:195], v29 offset:0
    ds_read_b64_tr_b16 v[216:217], v36 offset:4096
    s_waitcnt lgkmcnt(8)
    v_mfma_f32_32x32x16_bf16 v[72:87], v[188:191], v[200:203], v[72:87]
    ds_read_b64_tr_b16 v[218:219], v36 offset:4352
    ds_read_b128 v[196:199], v29 offset:2048
    s_waitcnt lgkmcnt(8)
    v_mfma_f32_32x32x16_bf16 v[88:103], v[184:187], v[204:207], v[88:103]
    ds_read_b64_tr_b16 v[220:221], v36 offset:16384
    ds_read_b64_tr_b16 v[222:223], v36 offset:16640
    v_mfma_f32_32x32x16_bf16 v[104:119], v[188:191], v[204:207], v[104:119]
    ds_read_b64_tr_b16 v[224:225], v36 offset:5120
    ds_read_b64_tr_b16 v[226:227], v36 offset:5376
    s_waitcnt lgkmcnt(10)
    v_mfma_f32_32x32x16_bf16 v[120:135], v[184:187], v[208:211], v[120:135]
    ds_read_b64_tr_b16 v[228:229], v36 offset:17408
    ds_read_b64_tr_b16 v[230:231], v36 offset:17664
    v_mfma_f32_32x32x16_bf16 v[136:151], v[188:191], v[208:211], v[136:151]
    global_load_dwordx2 v[44:45], v4, s[40:41] sc0 sc1
    s_waitcnt lgkmcnt(10)
    v_mfma_f32_32x32x16_bf16 v[152:167], v[184:187], v[212:215], v[152:167]
    v_mfma_f32_32x32x16_bf16 v[168:183], v[188:191], v[212:215], v[168:183]
    s_waitcnt lgkmcnt(7)
    v_mfma_f32_32x32x16_bf16 v[56:71], v[192:195], v[216:219], v[56:71]
    ds_read_b128 v[184:187], v30 offset:0
    ds_read_b64_tr_b16 v[200:201], v36 offset:7168
    s_waitcnt lgkmcnt(8)
    v_mfma_f32_32x32x16_bf16 v[72:87], v[196:199], v[216:219], v[72:87]
    ds_read_b64_tr_b16 v[202:203], v36 offset:7424
    ds_read_b128 v[188:191], v30 offset:2048
    s_waitcnt lgkmcnt(8)
    v_mfma_f32_32x32x16_bf16 v[88:103], v[192:195], v[220:223], v[88:103]
    ds_read_b64_tr_b16 v[204:205], v36 offset:19456
    v_mfma_f32_32x32x16_bf16 v[104:119], v[196:199], v[220:223], v[104:119]
    ds_read_b64_tr_b16 v[206:207], v36 offset:19712
    ds_read_b64_tr_b16 v[208:209], v36 offset:8192
    s_waitcnt lgkmcnt(9)
    v_mfma_f32_32x32x16_bf16 v[120:135], v[192:195], v[224:227], v[120:135]
    ds_read_b64_tr_b16 v[210:211], v36 offset:8448
    ds_read_b64_tr_b16 v[212:213], v36 offset:20480
    v_mfma_f32_32x32x16_bf16 v[136:151], v[196:199], v[224:227], v[136:151]
    ds_read_b64_tr_b16 v[214:215], v36 offset:20736
    s_waitcnt lgkmcnt(10)
    v_mfma_f32_32x32x16_bf16 v[152:167], v[192:195], v[228:231], v[152:167]
    v_mfma_f32_32x32x16_bf16 v[168:183], v[196:199], v[228:231], v[168:183]
    s_waitcnt lgkmcnt(7)
    v_mfma_f32_32x32x16_bf16 v[56:71], v[184:187], v[200:203], v[56:71]
    ds_read_b128 v[192:195], v31 offset:0
    ds_read_b64_tr_b16 v[216:217], v36 offset:10240
    s_waitcnt lgkmcnt(8)
    v_mfma_f32_32x32x16_bf16 v[72:87], v[188:191], v[200:203], v[72:87]
    ds_read_b64_tr_b16 v[218:219], v36 offset:10496
    ds_read_b128 v[196:199], v31 offset:2048
    s_waitcnt lgkmcnt(8)
    v_mfma_f32_32x32x16_bf16 v[88:103], v[184:187], v[204:207], v[88:103]
    ds_read_b64_tr_b16 v[220:221], v36 offset:22528
    v_mfma_f32_32x32x16_bf16 v[104:119], v[188:191], v[204:207], v[104:119]
    ds_read_b64_tr_b16 v[222:223], v36 offset:22784
    ds_read_b64_tr_b16 v[224:225], v36 offset:11264
    s_waitcnt lgkmcnt(9)
    v_mfma_f32_32x32x16_bf16 v[120:135], v[184:187], v[208:211], v[120:135]
    ds_read_b64_tr_b16 v[226:227], v36 offset:11520
    ds_read_b64_tr_b16 v[228:229], v36 offset:23552
    v_mfma_f32_32x32x16_bf16 v[136:151], v[188:191], v[208:211], v[136:151]
    ds_read_b64_tr_b16 v[230:231], v36 offset:23808
    s_waitcnt lgkmcnt(10)
    v_mfma_f32_32x32x16_bf16 v[152:167], v[184:187], v[212:215], v[152:167]
    v_mfma_f32_32x32x16_bf16 v[168:183], v[188:191], v[212:215], v[168:183]
    s_waitcnt lgkmcnt(0)
    s_barrier
    v_mfma_f32_32x32x16_bf16 v[56:71], v[192:195], v[216:219], v[56:71]
    v_add_u32 v28, 49152, v28
    v_add_u32 v36, 49152, v36
    ds_read_b128 v[184:187], v28 offset:0
    v_mfma_f32_32x32x16_bf16 v[72:87], v[196:199], v[216:219], v[72:87]
    ds_read_b64_tr_b16 v[200:201], v36 offset:1024
    ds_read_b64_tr_b16 v[202:203], v36 offset:1280
    v_mfma_f32_32x32x16_bf16 v[88:103], v[192:195], v[220:223], v[88:103]
    ds_read_b128 v[188:191], v28 offset:2048
    ds_read_b64_tr_b16 v[204:205], v36 offset:13312
    ds_read_b64_tr_b16 v[206:207], v36 offset:13568
    v_mfma_f32_32x32x16_bf16 v[104:119], v[196:199], v[220:223], v[104:119]
    ds_read_b64_tr_b16 v[208:209], v36 offset:2048
    ds_read_b64_tr_b16 v[210:211], v36 offset:2304
    v_mfma_f32_32x32x16_bf16 v[120:135], v[192:195], v[224:227], v[120:135]
    ds_read_b64_tr_b16 v[212:213], v36 offset:14336
    ds_read_b64_tr_b16 v[214:215], v36 offset:14592
    v_add_u32 v29, 49152, v29
    v_mfma_f32_32x32x16_bf16 v[136:151], v[196:199], v[224:227], v[136:151]
    v_add_u32 v30, 49152, v30
    v_add_u32 v31, 49152, v31
    v_mfma_f32_32x32x16_bf16 v[152:167], v[192:195], v[228:231], v[152:167]
    v_mfma_f32_32x32x16_bf16 v[168:183], v[196:199], v[228:231], v[168:183]
    s_waitcnt lgkmcnt(7)
    v_mfma_f32_32x32x16_bf16 v[56:71], v[184:187], v[200:203], v[56:71]
    ds_read_b128 v[192:195], v29 offset:0
    ds_read_b64_tr_b16 v[216:217], v36 offset:4096
    s_waitcnt lgkmcnt(8)
    v_mfma_f32_32x32x16_bf16 v[72:87], v[188:191], v[200:203], v[72:87]
    ds_read_b64_tr_b16 v[218:219], v36 offset:4352
    ds_read_b128 v[196:199], v29 offset:2048
    s_waitcnt lgkmcnt(8)
    v_mfma_f32_32x32x16_bf16 v[88:103], v[184:187], v[204:207], v[88:103]
    ds_read_b64_tr_b16 v[220:221], v36 offset:16384
    v_mfma_f32_32x32x16_bf16 v[104:119], v[188:191], v[204:207], v[104:119]
    ds_read_b64_tr_b16 v[222:223], v36 offset:16640
    ds_read_b64_tr_b16 v[224:225], v36 offset:5120
    s_waitcnt lgkmcnt(9)
    v_mfma_f32_32x32x16_bf16 v[120:135], v[184:187], v[208:211], v[120:135]
    ds_read_b64_tr_b16 v[226:227], v36 offset:5376
    ds_read_b64_tr_b16 v[228:229], v36 offset:17408
    v_mfma_f32_32x32x16_bf16 v[136:151], v[188:191], v[208:211], v[136:151]
    ds_read_b64_tr_b16 v[230:231], v36 offset:17664
    s_waitcnt lgkmcnt(10)
    v_mfma_f32_32x32x16_bf16 v[152:167], v[184:187], v[212:215], v[152:167]
    v_mfma_f32_32x32x16_bf16 v[168:183], v[188:191], v[212:215], v[168:183]
    s_waitcnt lgkmcnt(7)
    v_mfma_f32_32x32x16_bf16 v[56:71], v[192:195], v[216:219], v[56:71]
    ds_read_b128 v[184:187], v30 offset:0
    ds_read_b64_tr_b16 v[200:201], v36 offset:7168
    s_waitcnt lgkmcnt(8)
    v_mfma_f32_32x32x16_bf16 v[72:87], v[196:199], v[216:219], v[72:87]
    ds_read_b64_tr_b16 v[202:203], v36 offset:7424
    ds_read_b128 v[188:191], v30 offset:2048
    s_waitcnt lgkmcnt(8)
    v_mfma_f32_32x32x16_bf16 v[88:103], v[192:195], v[220:223], v[88:103]
    ds_read_b64_tr_b16 v[204:205], v36 offset:19456
    v_mfma_f32_32x32x16_bf16 v[104:119], v[196:199], v[220:223], v[104:119]
    ds_read_b64_tr_b16 v[206:207], v36 offset:19712
    ds_read_b64_tr_b16 v[208:209], v36 offset:8192
    s_waitcnt lgkmcnt(9)
    v_mfma_f32_32x32x16_bf16 v[120:135], v[192:195], v[224:227], v[120:135]
    ds_read_b64_tr_b16 v[210:211], v36 offset:8448
    ds_read_b64_tr_b16 v[212:213], v36 offset:20480
    v_mfma_f32_32x32x16_bf16 v[136:151], v[196:199], v[224:227], v[136:151]
    ds_read_b64_tr_b16 v[214:215], v36 offset:20736
    s_waitcnt lgkmcnt(10)
    v_mfma_f32_32x32x16_bf16 v[152:167], v[192:195], v[228:231], v[152:167]
    v_mfma_f32_32x32x16_bf16 v[168:183], v[196:199], v[228:231], v[168:183]
    s_waitcnt lgkmcnt(7)
    v_mfma_f32_32x32x16_bf16 v[56:71], v[184:187], v[200:203], v[56:71]
    ds_read_b128 v[192:195], v31 offset:0
    ds_read_b64_tr_b16 v[216:217], v36 offset:10240
    ds_read_b64_tr_b16 v[218:219], v36 offset:10496
    ds_read_b128 v[196:199], v31 offset:2048
    s_waitcnt lgkmcnt(10)
    v_mfma_f32_32x32x16_bf16 v[72:87], v[188:191], v[200:203], v[72:87]
    ds_read_b64_tr_b16 v[220:221], v36 offset:22528
    ds_read_b64_tr_b16 v[222:223], v36 offset:22784
    ds_read_b64_tr_b16 v[224:225], v36 offset:11264
    ds_read_b64_tr_b16 v[226:227], v36 offset:11520
    s_waitcnt lgkmcnt(12)
    v_mfma_f32_32x32x16_bf16 v[88:103], v[184:187], v[204:207], v[88:103]
    ds_read_b64_tr_b16 v[228:229], v36 offset:23552
    ds_read_b64_tr_b16 v[230:231], v36 offset:23808
    v_cmp_eq_u32 vcc, 1, v2
    v_mov_b32 v11, 154112
    v_mfma_f32_32x32x16_bf16 v[104:119], v[188:191], v[204:207], v[104:119]
    v_add_u32 v16, 0, v37
    v_cndmask_b32 v16, v16, v11, vcc
    v_add_u32 v17, 256, v37
    v_cndmask_b32 v17, v17, v11, vcc
    s_waitcnt lgkmcnt(12)
    v_mfma_f32_32x32x16_bf16 v[120:135], v[184:187], v[208:211], v[120:135]
    v_add_u32 v18, 0, v38
    v_cndmask_b32 v18, v18, v11, vcc
    v_add_u32 v19, 512, v38
    v_cndmask_b32 v19, v19, v11, vcc
    v_mfma_f32_32x32x16_bf16 v[136:151], v[188:191], v[208:211], v[136:151]
    v_add_u32 v20, 1024, v38
    v_cndmask_b32 v20, v20, v11, vcc
    v_add_u32 v21, 1536, v38
    v_cndmask_b32 v21, v21, v11, vcc
    s_waitcnt lgkmcnt(10)
    v_mfma_f32_32x32x16_bf16 v[152:167], v[184:187], v[212:215], v[152:167]
    v_mfma_f32_32x32x16_bf16 v[168:183], v[188:191], v[212:215], v[168:183]
    s_waitcnt lgkmcnt(0)
    s_barrier
    v_mfma_f32_32x32x16_bf16 v[56:71], v[192:195], v[216:219], v[56:71]
    ds_read_b128 v[184:187], v16
    v_mfma_f32_32x32x16_bf16 v[72:87], v[196:199], v[216:219], v[72:87]
    ds_read_b128 v[188:191], v17
    v_mfma_f32_32x32x16_bf16 v[88:103], v[192:195], v[220:223], v[88:103]
    ds_read_b128 v[200:203], v18
    v_mfma_f32_32x32x16_bf16 v[104:119], v[196:199], v[220:223], v[104:119]
    ds_read_b128 v[204:207], v19
    v_mfma_f32_32x32x16_bf16 v[120:135], v[192:195], v[224:227], v[120:135]
    ds_read_b128 v[208:211], v20
    v_mfma_f32_32x32x16_bf16 v[136:151], v[196:199], v[224:227], v[136:151]
    ds_read_b128 v[212:215], v21
    v_mfma_f32_32x32x16_bf16 v[152:167], v[192:195], v[228:231], v[152:167]
    v_mfma_f32_32x32x16_bf16 v[168:183], v[196:199], v[228:231], v[168:183]
    s_waitcnt lgkmcnt(3)
    v_mfma_f32_32x32x16_bf16 v[56:71], v[184:187], v[200:203], v[56:71]
    v_mfma_f32_32x32x16_bf16 v[72:87], v[188:191], v[200:203], v[72:87]
    s_waitcnt lgkmcnt(2)
    v_mfma_f32_32x32x16_bf16 v[88:103], v[184:187], v[204:207], v[88:103]
    v_mfma_f32_32x32x16_bf16 v[104:119], v[188:191], v[204:207], v[104:119]
    s_waitcnt lgkmcnt(1)
    v_mfma_f32_32x32x16_bf16 v[120:135], v[184:187], v[208:211], v[120:135]
    v_mfma_f32_32x32x16_bf16 v[136:151], v[188:191], v[208:211], v[136:151]
    s_waitcnt lgkmcnt(0)
    v_mfma_f32_32x32x16_bf16 v[152:167], v[184:187], v[212:215], v[152:167]
    v_mfma_f32_32x32x16_bf16 v[168:183], v[188:191], v[212:215], v[168:183]
    s_waitcnt vmcnt(0)
    v_readfirstlane_b32 s46, v44
    v_readfirstlane_b32 s47, v45
    s_cmp_lg_u32 s46, 0
    s_cbranch_scc1 L_cn1_ok
L_cn1_retry:
    s_add_u32 s3, s3, 1
    s_cmp_gt_u32 s3, 1048576
    s_cbranch_scc1 L_cn1_ok
    global_load_dwordx2 v[44:45], v4, s[40:41] sc0 sc1
    s_waitcnt vmcnt(0)
    v_readfirstlane_b32 s46, v44
    v_readfirstlane_b32 s47, v45
    s_nop 1
    s_cmp_lg_u32 s46, 0
    s_cbranch_scc0 L_cn1_retry
L_cn1_ok:
    s_nop 4
    v_max_f32 v56, 0, v56
    v_max_f32 v57, 0, v57
    v_max_f32 v58, 0, v58
    v_max_f32 v59, 0, v59
    v_max_f32 v60, 0, v60
    v_max_f32 v61, 0, v61
    v_max_f32 v62, 0, v62
    v_max_f32 v63, 0, v63
    v_max_f32 v64, 0, v64
    v_max_f32 v65, 0, v65
    v_max_f32 v66, 0, v66
    v_max_f32 v67, 0, v67
    v_max_f32 v68, 0, v68
    v_max_f32 v69, 0, v69
    v_max_f32 v70, 0, v70
    v_max_f32 v71, 0, v71
    v_pk_mul_f32 v[56:57], v[56:57], v[88:89]
    v_pk_mul_f32 v[58:59], v[58:59], v[90:91]
    v_pk_mul_f32 v[60:61], v[60:61], v[92:93]
    v_pk_mul_f32 v[62:63], v[62:63], v[94:95]
    v_pk_mul_f32 v[64:65], v[64:65], v[96:97]
    v_pk_mul_f32 v[66:67], v[66:67], v[98:99]
    v_pk_mul_f32 v[68:69], v[68:69], v[100:101]
    v_pk_mul_f32 v[70:71], v[70:71], v[102:103]
    v_cvt_pk_bf16_f32 v184, v56, v58
    v_cvt_pk_bf16_f32 v185, v60, v62
    v_cvt_pk_bf16_f32 v186, v64, v66
    v_cvt_pk_bf16_f32 v187, v68, v70
    buffer_store_dwordx4 v[184:187], v40, s[64:67], s85 offen offset:0 sc0 sc1
    v_cvt_pk_bf16_f32 v188, v57, v59
    v_cvt_pk_bf16_f32 v189, v61, v63
    v_cvt_pk_bf16_f32 v190, v65, v67
    v_cvt_pk_bf16_f32 v191, v69, v71
    buffer_store_dwordx4 v[188:191], v41, s[64:67], s85 offen offset:0 sc0 sc1
    v_max_f32 v72, 0, v72
    v_max_f32 v73, 0, v73
    v_max_f32 v74, 0, v74
    v_max_f32 v75, 0, v75
    v_max_f32 v76, 0, v76
    v_max_f32 v77, 0, v77
    v_max_f32 v78, 0, v78
    v_max_f32 v79, 0, v79
    v_max_f32 v80, 0, v80
    v_max_f32 v81, 0, v81
    v_max_f32 v82, 0, v82
    v_max_f32 v83, 0, v83
    v_max_f32 v84, 0, v84
    v_max_f32 v85, 0, v85
    v_max_f32 v86, 0, v86
    v_max_f32 v87, 0, v87
    v_pk_mul_f32 v[72:73], v[72:73], v[104:105]
    v_pk_mul_f32 v[74:75], v[74:75], v[106:107]
    v_pk_mul_f32 v[76:77], v[76:77], v[108:109]
    v_pk_mul_f32 v[78:79], v[78:79], v[110:111]
    v_pk_mul_f32 v[80:81], v[80:81], v[112:113]
    v_pk_mul_f32 v[82:83], v[82:83], v[114:115]
    v_pk_mul_f32 v[84:85], v[84:85], v[116:117]
    v_pk_mul_f32 v[86:87], v[86:87], v[118:119]
    v_cvt_pk_bf16_f32 v192, v72, v74
    v_cvt_pk_bf16_f32 v193, v76, v78
    v_cvt_pk_bf16_f32 v194, v80, v82
    v_cvt_pk_bf16_f32 v195, v84, v86
    buffer_store_dwordx4 v[192:195], v42, s[64:67], s85 offen offset:0 sc0 sc1
    v_cvt_pk_bf16_f32 v196, v73, v75
    v_cvt_pk_bf16_f32 v197, v77, v79
    v_cvt_pk_bf16_f32 v198, v81, v83
    v_cvt_pk_bf16_f32 v199, v85, v87
    buffer_store_dwordx4 v[196:199], v43, s[64:67], s85 offen offset:0 sc0 sc1
    v_max_f32 v120, 0, v120
    v_max_f32 v121, 0, v121
    v_max_f32 v122, 0, v122
    v_max_f32 v123, 0, v123
    v_max_f32 v124, 0, v124
    v_max_f32 v125, 0, v125
    v_max_f32 v126, 0, v126
    v_max_f32 v127, 0, v127
    v_max_f32 v128, 0, v128
    v_max_f32 v129, 0, v129
    v_max_f32 v130, 0, v130
    v_max_f32 v131, 0, v131
    v_max_f32 v132, 0, v132
    v_max_f32 v133, 0, v133
    v_max_f32 v134, 0, v134
    v_max_f32 v135, 0, v135
    v_pk_mul_f32 v[120:121], v[120:121], v[152:153]
    v_pk_mul_f32 v[122:123], v[122:123], v[154:155]
    v_pk_mul_f32 v[124:125], v[124:125], v[156:157]
    v_pk_mul_f32 v[126:127], v[126:127], v[158:159]
    v_pk_mul_f32 v[128:129], v[128:129], v[160:161]
    v_pk_mul_f32 v[130:131], v[130:131], v[162:163]
    v_pk_mul_f32 v[132:133], v[132:133], v[164:165]
    v_pk_mul_f32 v[134:135], v[134:135], v[166:167]
    v_cvt_pk_bf16_f32 v200, v120, v122
    v_cvt_pk_bf16_f32 v201, v124, v126
    v_cvt_pk_bf16_f32 v202, v128, v130
    v_cvt_pk_bf16_f32 v203, v132, v134
    buffer_store_dwordx4 v[200:203], v40, s[64:67], s86 offen offset:0 sc0 sc1
    v_cvt_pk_bf16_f32 v204, v121, v123
    v_cvt_pk_bf16_f32 v205, v125, v127
    v_cvt_pk_bf16_f32 v206, v129, v131
    v_cvt_pk_bf16_f32 v207, v133, v135
    buffer_store_dwordx4 v[204:207], v41, s[64:67], s86 offen offset:0 sc0 sc1
    v_max_f32 v136, 0, v136
    v_max_f32 v137, 0, v137
    v_max_f32 v138, 0, v138
    v_max_f32 v139, 0, v139
    v_max_f32 v140, 0, v140
    v_max_f32 v141, 0, v141
    v_max_f32 v142, 0, v142
    v_max_f32 v143, 0, v143
    v_max_f32 v144, 0, v144
    v_max_f32 v145, 0, v145
    v_max_f32 v146, 0, v146
    v_max_f32 v147, 0, v147
    v_max_f32 v148, 0, v148
    v_max_f32 v149, 0, v149
    v_max_f32 v150, 0, v150
    v_max_f32 v151, 0, v151
    v_pk_mul_f32 v[136:137], v[136:137], v[168:169]
    v_pk_mul_f32 v[138:139], v[138:139], v[170:171]
    v_pk_mul_f32 v[140:141], v[140:141], v[172:173]
    v_pk_mul_f32 v[142:143], v[142:143], v[174:175]
    v_pk_mul_f32 v[144:145], v[144:145], v[176:177]
    v_pk_mul_f32 v[146:147], v[146:147], v[178:179]
    v_pk_mul_f32 v[148:149], v[148:149], v[180:181]
    v_pk_mul_f32 v[150:151], v[150:151], v[182:183]
    v_cvt_pk_bf16_f32 v208, v136, v138
    v_cvt_pk_bf16_f32 v209, v140, v142
    v_cvt_pk_bf16_f32 v210, v144, v146
    v_cvt_pk_bf16_f32 v211, v148, v150
    buffer_store_dwordx4 v[208:211], v42, s[64:67], s86 offen offset:0 sc0 sc1
    v_cvt_pk_bf16_f32 v212, v137, v139
    v_cvt_pk_bf16_f32 v213, v141, v143
    v_cvt_pk_bf16_f32 v214, v145, v147
    v_cvt_pk_bf16_f32 v215, v149, v151
    buffer_store_dwordx4 v[212:215], v43, s[64:67], s86 offen offset:0 sc0 sc1
    s_mov_b32 s68, s36
    s_mov_b32 s69, s37
    s_mov_b32 s70, 1409024
    s_mov_b32 s71, 0x20000
    s_mov_b32 s56, s28
    s_mov_b32 s57, s29
    s_mov_b32 s58, 524288
    s_mov_b32 s59, 0x20000
    v_lshrrev_b32 v8, 3, v1
    v_and_b32 v9, 7, v1
    v_bfe_u32 v10, v1, 4, 1
    v_lshlrev_b32 v10, 2, v10
    v_xor_b32 v10, v10, v9
    s_lshl_b32 s79, s83, 5
    v_add_u32 v11, s79, v8
    v_lshlrev_b32 v11, 10, v11
    v_lshl_add_u32 v11, v10, 4, v11
    s_lshl_b32 s79, s77, 7
    v_add_u32 v24, s79, v11
    v_lshrrev_b32 v8, 3, v1
    v_and_b32 v9, 7, v1
    v_lshrrev_b32 v10, 1, v8
    v_xor_b32 v10, v10, v9
    s_lshl_b32 s79, s77, 6
    s_lshl_b32 s80, s83, 5
    s_add_u32 s79, s79, s80
    v_add_u32 v11, s79, v8
    v_lshlrev_b32 v11, 10, v11
    v_lshl_add_u32 v28, v10, 4, v11
    v_xor_b32 v10, 4, v10
    v_lshl_add_u32 v29, v10, 4, v11
    s_lshl_b32 s79, s83, 12
    v_add_u32 v32, s79, v5
    s_waitcnt vmcnt(0)
    s_lshl_b32 s79, s92, 4
    s_add_u32 s79, s79, 11337736
    v_mov_b32 v8, s46
    v_mov_b32 v9, s47
    s_mov_b64 exec, 1
    buffer_store_dwordx2 v[8:9], v4, s[64:67], s79 offen sc0 sc1
    s_mov_b64 exec, -1
    s_endpgm
L_end:
    s_endpgm
.section .rodata,"a"
.p2align 6
.amdhsa_kernel recurrent_scan__ssm_conv_s5__glu_gated_reglu__prompt_kernel
  .amdhsa_next_free_vgpr 248
  .amdhsa_next_free_sgpr 102
  .amdhsa_accum_offset 248
  .amdhsa_group_segment_fixed_size 0
  .amdhsa_kernarg_size 128
  .amdhsa_user_sgpr_count 2
  .amdhsa_user_sgpr_kernarg_segment_ptr 1
  .amdhsa_system_sgpr_workgroup_id_x 1
  .amdhsa_float_denorm_mode_32 3
.end_amdhsa_kernel
```
